```python
import torch

def _softmax(x, axis=-1):
    return torch.softmax(x, dim=axis)
def _gelu(x):
    return torch.nn.functional.gelu(x, approximate="tanh")
def _silu(x):
    return torch.nn.functional.silu(x)
def _sigmoid(x):
    return torch.sigmoid(x)
def _layernorm(x, axis=-1, eps=1e-5):
    m = x.mean(dim=axis, keepdim=True)
    v = x.var(dim=axis, keepdim=True, unbiased=False)
    return (x - m) / torch.sqrt(v + eps)
def _scatter_add(tgt, idx, src, axis=0):
    return tgt.clone().index_add_(axis, idx, src)
def _segment_sum(src, seg, n):
    out = torch.zeros((n,) + src.shape[1:], dtype=src.dtype)
    return out.index_add_(0, seg, src)
def _pad(x, pw):
    flat = tuple(v for pair in reversed(pw) for v in pair)
    return torch.nn.functional.pad(x, flat)

kernel_name = 'gather_scatter__cheap_equivariant_egnn__graph'

def setup_inputs():

    _w = (lambda a: (lambda t: t.to(torch.bfloat16) if t.is_floating_point() else t)(torch.as_tensor(a)))
    N, deg, D, De = 25000, 32, 64, max(4, 1)
    E = N * deg
    return {
        "h": _w((lambda *s: torch.randn(*s, dtype=torch.bfloat16) * 0.2)(N, D)),
        "pos": _w((lambda *s: torch.randn(*s, dtype=torch.bfloat16) * 0.8)(N, 3)),
        "e_attr": _w((lambda *s: torch.randn(*s, dtype=torch.bfloat16) * 0.8)(E, De)),
        "src": _w((lambda lo, hi, *s: torch.randint(lo, hi, s))(0, N, E).to(torch.int64)),
        "dst": _w((lambda lo, hi, *s: torch.randint(lo, hi, s))(0, N, E).to(torch.int64)),
        "w_e": _w(0.1 * (lambda *s: torch.randn(*s, dtype=torch.bfloat16) * 0.8)(2 * D + 1 + De, D)),
        "w_x": _w(0.1 * (lambda *s: torch.randn(*s, dtype=torch.bfloat16) * 0.2)(D, 1)),
        "w_h": _w(0.1 * (lambda *s: torch.randn(*s, dtype=torch.bfloat16) * 0.2)(2 * D, D)),
    }

def reference(h, pos, e_attr, src, dst, w_e, w_x, w_h):
    N, D = h.shape[0], h.shape[1]
    diff = pos[dst] - pos[src]
    dist2 = torch.sum(diff * diff, axis=-1, keepdims=True)
    e_in = torch.concatenate([h[dst], h[src], dist2, e_attr], axis=-1)
    m_ij = _silu(e_in @ w_e)
    coord_scale = m_ij @ w_x
    pos_new = pos + _segment_sum(diff * coord_scale, dst, N)
    m_i = _segment_sum(m_ij, dst, N)
    h_new = h + _silu(torch.concatenate([h, m_i], axis=-1) @ w_h)
    return h_new, pos_new
```

```asm
; @launch grid=(256,1,1) block=(512,1,1) lds=162944
.amdgcn_target "amdgcn-amd-amdhsa--gfx950"
.text
.globl gather_scatter__cheap_equivariant_egnn__graph_kernel
.p2align 8
.type gather_scatter__cheap_equivariant_egnn__graph_kernel,@function
gather_scatter__cheap_equivariant_egnn__graph_kernel:
    s_cmp_ge_u32 s2, 256
    s_cbranch_scc1 L_done
    s_load_dwordx16 s[4:19], s[0:1], 0
    s_and_b32 s3, s2, 7
    s_lshl_b32 s3, s3, 5
    s_lshr_b32 s2, s2, 3
    s_or_b32 s2, s2, s3
    s_load_dwordx4 s[20:23], s[0:1], 64
    s_load_dwordx2 s[24:25], s[0:1], 80
    v_lshrrev_b32 v78, 6, v0
    v_and_b32 v1, 63, v0
    v_readfirstlane_b32 s52, v78
    v_mov_b32 v235, 0
    v_lshlrev_b32 v82, 4, v0
    v_lshlrev_b32 v81, 5, v0
    v_lshlrev_b32 v83, 4, v1
    v_mov_b64 v[164:165], 0
    v_mov_b64 v[166:167], 0
    s_mul_i32 s66, s2, 12544
    s_lshl_b32 s68, s66, 1
    s_mov_b32 s65, 3136
    s_cmp_eq_u32 s2, 255
    s_cselect_b32 s65, 320, s65
    s_lshl_b32 s3, s65, 2
    s_add_u32 s3, s3, s66
    s_lshl_b32 s69, s3, 1
    s_add_u32 s63, s66, 8192
    s_add_u32 s64, s68, 16384
    s_lshl_b32 s56, s2, 10
    s_mul_i32 s57, s2, 98
    v_and_b32 v2, 127, v0
    v_add_u32 v2, s57, v2
    v_mul_u32_u24 v2, 6, v2
    v_and_b32 v214, 2, v2
    v_lshlrev_b32 v214, 3, v214
    v_and_b32 v2, -4, v2
    v_and_b32 v243, 3, v1
    v_bfe_u32 v244, v1, 2, 3
    v_lshl_or_b32 v243, v244, 3, v243
    v_lshrrev_b32 v244, 5, v1
    v_lshl_or_b32 v243, v244, 2, v243
    v_lshlrev_b32 v243, 1, v243
    s_waitcnt lgkmcnt(0)
    s_add_u32 s40, s24, 9633792
    s_addc_u32 s41, s25, 0
    s_mov_b32 s42, 262144
    s_mov_b32 s43, 0x00020000
    s_cmp_lg_u32 s52, 0
    s_cbranch_scc1 L_noclr
    buffer_store_dwordx4 v[164:167], v83, s[40:43], s56 offen sc1
L_noclr:
    s_mov_b32 s84, s6
    s_mov_b32 s85, s7
    s_mov_b32 s86, 150000
    s_mov_b32 s87, 0x00020000
    s_mov_b32 s48, s16
    s_mov_b32 s49, s17
    s_mov_b32 s50, 128
    s_mov_b32 s51, 0x00020000
    s_cmp_gt_u32 s52, 4
    s_cbranch_scc1 L_nopos
    s_cmp_eq_u32 s52, 4
    s_cbranch_scc1 L_wx
    buffer_load_dwordx2 v[212:213], v2, s[84:87], 0 offen
    s_branch L_nopos
L_wx:
    buffer_load_ushort v215, v243, s[48:51], 0 offen
L_nopos:
    s_mov_b32 s72, s12
    s_mov_b32 s73, s13
    s_mov_b32 s74, s3
    s_mov_b32 s75, 0x00020000
    v_lshlrev_b32 v80, 3, v0
    s_add_u32 s64, s66, 4096
    buffer_load_dwordx2 v[4:5], v80, s[72:75], s66 offen nt
    buffer_load_dwordx2 v[6:7], v80, s[72:75], s64 offen nt
    s_add_u32 s64, s63, 4096
    buffer_load_dwordx2 v[8:9], v80, s[72:75], s63 offen nt
    buffer_load_dwordx2 v[10:11], v80, s[72:75], s64 offen nt
    s_mov_b32 s76, s10
    s_mov_b32 s77, s11
    s_mov_b32 s78, s3
    s_mov_b32 s79, 0x00020000
    s_mov_b32 s80, s8
    s_mov_b32 s81, s9
    s_mov_b32 s82, s69
    s_mov_b32 s83, 0x00020000
    v_add_u32 v3, 146560, v83
    ds_write_b128 v3, v[164:167]
    s_lshl_b32 s55, s2, 2
    s_lshr_b32 s53, s52, 1
    s_and_b32 s54, s52, 1
    s_add_u32 s28, s24, 11006976
    s_addc_u32 s29, s25, 0
    s_mov_b32 s30, 3203072
    s_mov_b32 s31, 0x00020000
    s_mov_b32 s36, s24
    s_mov_b32 s37, s25
    s_mov_b32 s38, 9633792
    s_mov_b32 s39, 0x00020000
    s_add_u32 s32, s24, 9895936
    s_addc_u32 s33, s25, 0
    s_mov_b32 s34, 25000
    s_mov_b32 s35, 0x00020000
    s_and_b32 s33, s33, 0xffff
    s_or_b32 s33, s33, 0x80000
    s_sub_u32 s62, 25000, s57
    s_min_u32 s62, s62, 98
    s_lshl_b32 s63, s57, 7
    s_lshl_b32 s64, s62, 7
    s_add_u32 s44, s20, s63
    s_addc_u32 s45, s21, 0
    s_mov_b32 s46, s64
    s_mov_b32 s47, 0x00020000
    s_mul_i32 s63, s57, 6
    s_add_u32 s63, s63, 3200000
    s_mul_i32 s64, s62, 6
    s_add_u32 s48, s20, s63
    s_addc_u32 s49, s21, 0
    s_mov_b32 s50, s64
    s_mov_b32 s51, 0x00020000
    buffer_load_dwordx2 v[12:13], v80, s[76:79], s66 offen nt
    buffer_load_dwordx4 v[20:23], v82, s[80:83], s68 offen nt
    s_add_u32 s66, s66, 4096
    s_add_u32 s68, s68, 8192
    buffer_load_dwordx2 v[14:15], v80, s[76:79], s66 offen nt
    buffer_load_dwordx4 v[24:27], v82, s[80:83], s68 offen nt
    s_add_u32 s66, s66, 4096
    s_add_u32 s68, s68, 8192
    buffer_load_dwordx2 v[16:17], v80, s[76:79], s66 offen nt
    buffer_load_dwordx4 v[28:31], v82, s[80:83], s68 offen nt
    s_add_u32 s66, s66, 4096
    s_add_u32 s68, s68, 8192
    buffer_load_dwordx2 v[18:19], v80, s[76:79], s66 offen nt
    buffer_load_dwordx4 v[32:35], v82, s[80:83], s68 offen nt
    s_mul_i32 s63, s2, 37632
    s_mul_i32 s64, s65, 12
    s_add_u32 s72, s24, s63
    s_addc_u32 s73, s25, 0
    s_mov_b32 s74, s64
    s_mov_b32 s75, 0x00020000
    s_mov_b32 s76, s22
    s_mov_b32 s77, s23
    s_mov_b32 s78, 256
    s_mov_b32 s79, 0x00020000
    v_mov_b32 v218, 1
    s_lshr_b32 s3, s65, 1
    v_cmp_gt_u32 s[80:81], s3, v0
    v_add_u32 v2, 512, v0
    v_cmp_gt_u32 s[82:83], s3, v2
    v_add_u32 v2, 1024, v0
    v_cmp_gt_u32 s[84:85], s3, v2
    v_add_u32 v2, 1536, v0
    v_cmp_gt_u32 s[86:87], s3, v2
    s_mov_b32 s58, 0xbfb8aa3b
    s_mov_b32 s59, 0xbfb8aa3b
    s_mov_b32 s60, 1.0
    s_mov_b32 s61, 1.0
    s_mov_b32 s56, 0
    s_mov_b32 s67, 0x40000
    ds_write_b128 v83, v[164:167] offset:8192
    v_mov_b32 v3, 146432
    ds_write_b128 v3, v[164:167]
    v_add_u32 v3, 86016, v82
    ds_write_b128 v3, v[164:167] offset:0
    ds_write_b128 v3, v[164:167] offset:8192
    v_and_b32 v78, 31, v1
    v_lshrrev_b32 v79, 5, v1
    s_lshl_b32 s63, s52, 12
    s_add_u32 s63, s63, 53248
    s_mov_b32 m0, s63
    v_and_b32 v2, 3, v78
    v_lshlrev_b32 v3, 10, v2
    v_lshrrev_b32 v243, 2, v78
    v_lshl_add_u32 v3, v243, 7, v3
    v_add_u32 v3, s63, v3
    v_bfe_u32 v243, v78, 3, 1
    v_lshl_or_b32 v2, v243, 2, v2
    v_xor_b32 v2, v2, v79
    v_xor_b32 v243, 0, v2
    v_lshl_add_u32 v220, v243, 4, v3
    v_xor_b32 v243, 2, v2
    v_lshl_add_u32 v221, v243, 4, v3
    v_xor_b32 v243, 4, v2
    v_lshl_add_u32 v222, v243, 4, v3
    v_xor_b32 v243, 6, v2
    v_lshl_add_u32 v223, v243, 4, v3
    v_and_b32 v2, 7, v1
    v_bfe_u32 v3, v1, 4, 1
    v_lshlrev_b32 v3, 2, v3
    v_xor_b32 v2, v2, v3
    v_xor_b32 v243, 0, v2
    v_lshlrev_b32 v224, 4, v243
    v_xor_b32 v243, 1, v2
    v_lshlrev_b32 v225, 4, v243
    v_xor_b32 v243, 2, v2
    v_lshlrev_b32 v226, 4, v243
    v_xor_b32 v243, 3, v2
    v_lshlrev_b32 v227, 4, v243
    s_lshl_b32 s63, s52, 11
    s_add_u32 s63, s63, 86016
    v_bfe_u32 v2, v78, 1, 3
    v_lshlrev_b32 v2, 3, v2
    v_lshl_add_u32 v2, v78, 6, v2
    v_add_u32 v230, s63, v2
    v_bfe_u32 v2, v1, 2, 2
    v_lshl_add_u32 v2, v79, 2, v2
    v_bfe_u32 v3, v1, 4, 1
    v_and_b32 v243, 3, v1
    v_lshl_or_b32 v3, v3, 2, v243
    v_lshlrev_b32 v239, 3, v3
    v_bfe_u32 v243, v1, 2, 2
    v_lshl_add_u32 v239, v243, 7, v239
    v_lshrrev_b32 v243, 1, v2
    v_xor_b32 v3, v3, v243
    v_lshlrev_b32 v2, 6, v2
    v_add_u32 v2, s63, v2
    v_lshl_add_u32 v231, v3, 3, v2
    v_xor_b32 v3, 4, v3
    v_lshl_add_u32 v232, v3, 3, v2
    v_add_u32 v232, 512, v232
    v_lshlrev_b32 v2, 4, v78
    v_add_u32 v233, 102400, v2
    v_lshrrev_b32 v2, 2, v78
    v_mul_u32_u24 v2, 272, v2
    v_add_u32 v2, 115712, v2
    v_lshl_add_u32 v236, v79, 4, v2
    v_and_b32 v3, 3, v78
    v_lshl_add_u32 v237, v3, 2, v2
    v_add_u32 v237, 256, v237
    v_bfe_u32 v2, v78, 4, 1
    v_add_u32 v238, -1, v2
    v_lshrrev_b32 v244, 4, v0
    v_lshlrev_b32 v234, 10, v244
    v_and_b32 v2, 15, v0
    v_add_u32 v242, 0x8000, v2
    v_add_u32 v229, 0x8010, v2
    s_mov_b32 s63, 37632
    v_mul_lo_u32 v228, v244, s63
    v_mad_u32_u24 v228, v2, 12, v228
    v_mov_b32 v241, 0
    v_lshrrev_b32 v2, 3, v1
    v_and_b32 v3, 7, v1
    v_lshrrev_b32 v243, 4, v1
    s_lshl_b32 s3, s54, 2
    v_or_b32 v243, s3, v243
    v_xor_b32 v3, v3, v243
    v_lshlrev_b32 v3, 4, v3
    v_lshl_add_u32 v204, v2, 7, v3
    s_add_u32 s3, s57, 104
    s_min_u32 s3, s3, 25000
    s_lshl_b32 s3, s3, 7
    s_mov_b32 s88, s14
    s_mov_b32 s89, s15
    s_mov_b32 s90, 17024
    s_mov_b32 s91, 0x00020000
    s_mov_b32 s20, s18
    s_mov_b32 s21, s19
    s_mov_b32 s22, 16384
    s_mov_b32 s23, 0x00020000
    s_mov_b32 s96, s4
    s_mov_b32 s97, s5
    s_mov_b32 s98, s3
    s_mov_b32 s99, 0x00020000
    s_mov_b32 s63, 5350
    s_mov_b32 s64, 98
    s_mov_b32 s3, 146560
    s_waitcnt lgkmcnt(0)
    s_barrier
    s_cmp_lg_u32 s52, 0
    s_cbranch_scc1 L_noflag
    v_mov_b32 v3, s2
    s_waitcnt vmcnt(13)
    s_mov_b64 exec, 1
    buffer_store_byte v218, v3, s[76:79], 0 offen sc1
    s_mov_b64 exec, -1
L_noflag:
    s_waitcnt vmcnt(11)
    s_mov_b64 exec, s[80:81]
    v_mul_u32_u24 v36, s63, v4
    v_lshrrev_b32 v36, 19, v36
    v_mul_u32_u24 v2, s64, v36
    v_lshl_add_u32 v36, v36, 2, s3
    ds_add_rtn_u32 v44, v36, v218
    v_sub_u32 v4, v4, v2
    v_mul_u32_u24 v37, s63, v5
    v_lshrrev_b32 v37, 19, v37
    v_mul_u32_u24 v2, s64, v37
    v_lshl_add_u32 v37, v37, 2, s3
    ds_add_rtn_u32 v45, v37, v218
    v_sub_u32 v5, v5, v2
    s_waitcnt vmcnt(10)
    s_mov_b64 exec, s[82:83]
    v_mul_u32_u24 v38, s63, v6
    v_lshrrev_b32 v38, 19, v38
    v_mul_u32_u24 v2, s64, v38
    v_lshl_add_u32 v38, v38, 2, s3
    ds_add_rtn_u32 v46, v38, v218
    v_sub_u32 v6, v6, v2
    v_mul_u32_u24 v39, s63, v7
    v_lshrrev_b32 v39, 19, v39
    v_mul_u32_u24 v2, s64, v39
    v_lshl_add_u32 v39, v39, 2, s3
    ds_add_rtn_u32 v47, v39, v218
    v_sub_u32 v7, v7, v2
    s_waitcnt vmcnt(9)
    s_mov_b64 exec, s[84:85]
    v_mul_u32_u24 v40, s63, v8
    v_lshrrev_b32 v40, 19, v40
    v_mul_u32_u24 v2, s64, v40
    v_lshl_add_u32 v40, v40, 2, s3
    ds_add_rtn_u32 v48, v40, v218
    v_sub_u32 v8, v8, v2
    v_mul_u32_u24 v41, s63, v9
    v_lshrrev_b32 v41, 19, v41
    v_mul_u32_u24 v2, s64, v41
    v_lshl_add_u32 v41, v41, 2, s3
    ds_add_rtn_u32 v49, v41, v218
    v_sub_u32 v9, v9, v2
    s_waitcnt vmcnt(8)
    s_mov_b64 exec, s[86:87]
    v_mul_u32_u24 v42, s63, v10
    v_lshrrev_b32 v42, 19, v42
    v_mul_u32_u24 v2, s64, v42
    v_lshl_add_u32 v42, v42, 2, s3
    ds_add_rtn_u32 v50, v42, v218
    v_sub_u32 v10, v10, v2
    v_mul_u32_u24 v43, s63, v11
    v_lshrrev_b32 v43, 19, v43
    v_mul_u32_u24 v2, s64, v43
    v_lshl_add_u32 v43, v43, 2, s3
    ds_add_rtn_u32 v51, v43, v218
    v_sub_u32 v11, v11, v2
    s_mov_b64 exec, -1
    v_add_u32 v2, 146560, v83
    s_waitcnt lgkmcnt(0)
    s_barrier
    ds_read_b128 v[164:167], v2
    s_lshl_b32 s63, s52, 10
    s_add_u32 s64, s63, 8192
    s_cmp_lg_u32 s52, 1
    s_cbranch_scc1 L_nowe
    s_mov_b32 m0, 140288
    s_mov_b32 s3, 16384
    buffer_load_dwordx4 v83, s[88:91], s3 offen lds
L_nowe:
    s_add_u32 m0, s63, 123904
    s_lshl_b32 s3, s57, 7
    buffer_load_dwordx4 v83, s[88:91], s63 offen lds
    s_add_u32 m0, s63, 132096
    s_add_u32 s3, s3, s63
    buffer_load_dwordx4 v83, s[88:91], s64 offen lds
    s_add_u32 m0, s63, 61440
    s_add_u32 s69, s3, 8192
    buffer_load_dwordx4 v204, s[96:99], s3 offen lds
    s_add_u32 m0, s63, 69632
    s_lshl_b32 s63, s52, 12
    buffer_load_dwordx4 v204, s[96:99], s69 offen lds
    s_add_u32 m0, s63, 53248
    s_waitcnt lgkmcnt(0)
    v_add_u32 v169, v164, v165
    v_add_u32 v170, v169, v166
    v_add_u32 v171, v170, v167
    v_mov_b32 v168, v171
    s_nop 1
    v_add_u32_dpp v168, v168, v168 row_shr:1 row_mask:0xf bank_mask:0xf bound_ctrl:0
    s_nop 1
    v_add_u32_dpp v168, v168, v168 row_shr:2 row_mask:0xf bank_mask:0xf bound_ctrl:0
    s_nop 1
    v_add_u32_dpp v168, v168, v168 row_shr:4 row_mask:0xf bank_mask:0xf bound_ctrl:0
    s_nop 1
    v_add_u32_dpp v168, v168, v168 row_shr:8 row_mask:0xf bank_mask:0xf bound_ctrl:0
    s_nop 1
    v_add_u32_dpp v168, v168, v168 row_bcast:15 row_mask:0xa bank_mask:0xf
    s_nop 1
    v_add_u32_dpp v168, v168, v168 row_bcast:31 row_mask:0xc bank_mask:0xf
    v_sub_u32 v172, v168, v171
    v_add_u32 v173, v172, v164
    v_add_u32 v174, v172, v169
    v_add_u32 v175, v172, v170
    ds_write_b128 v2, v[172:175] offset:1024
    s_mov_b64 exec, s[80:81]
    ds_read_b32 v36, v36 offset:1024
    ds_read_b32 v37, v37 offset:1024
    s_mov_b64 exec, s[82:83]
    ds_read_b32 v38, v38 offset:1024
    ds_read_b32 v39, v39 offset:1024
    s_mov_b64 exec, s[84:85]
    ds_read_b32 v40, v40 offset:1024
    ds_read_b32 v41, v41 offset:1024
    s_mov_b64 exec, s[86:87]
    ds_read_b32 v42, v42 offset:1024
    ds_read_b32 v43, v43 offset:1024
    s_mov_b64 exec, -1
    v_mul_u32_u24 v64, 12, v172
    v_lshl_or_b32 v64, v164, 16, v64
    v_or_b32 v64, 0x80000000, v64
    v_mul_u32_u24 v65, 12, v173
    v_lshl_or_b32 v65, v165, 16, v65
    v_or_b32 v65, 0x80000000, v65
    v_mul_u32_u24 v66, 12, v174
    v_lshl_or_b32 v66, v166, 16, v66
    v_or_b32 v66, 0x80000000, v66
    v_mul_u32_u24 v67, 12, v175
    v_lshl_or_b32 v67, v167, 16, v67
    v_or_b32 v67, 0x80000000, v67
    s_waitcnt vmcnt(10) lgkmcnt(6)
    s_mov_b64 exec, s[80:81]
    v_add_lshl_u32 v36, v36, v44, 4
    v_lshl_or_b32 v12, v12, 7, v4
    ds_write_b64 v36, v[20:21] offset:10240
    ds_write_b32 v36, v12 offset:10248
    v_add_lshl_u32 v37, v37, v45, 4
    v_lshl_or_b32 v13, v13, 7, v5
    ds_write_b64 v37, v[22:23] offset:10240
    ds_write_b32 v37, v13 offset:10248
    s_waitcnt vmcnt(8) lgkmcnt(8)
    s_mov_b64 exec, s[82:83]
    v_add_lshl_u32 v38, v38, v46, 4
    v_lshl_or_b32 v14, v14, 7, v6
    ds_write_b64 v38, v[24:25] offset:10240
    ds_write_b32 v38, v14 offset:10248
    v_add_lshl_u32 v39, v39, v47, 4
    v_lshl_or_b32 v15, v15, 7, v7
    ds_write_b64 v39, v[26:27] offset:10240
    ds_write_b32 v39, v15 offset:10248
    s_waitcnt vmcnt(6) lgkmcnt(10)
    s_mov_b64 exec, s[84:85]
    v_add_lshl_u32 v40, v40, v48, 4
    v_lshl_or_b32 v16, v16, 7, v8
    ds_write_b64 v40, v[28:29] offset:10240
    ds_write_b32 v40, v16 offset:10248
    v_add_lshl_u32 v41, v41, v49, 4
    v_lshl_or_b32 v17, v17, 7, v9
    ds_write_b64 v41, v[30:31] offset:10240
    ds_write_b32 v41, v17 offset:10248
    s_waitcnt vmcnt(4) lgkmcnt(12)
    s_mov_b64 exec, s[86:87]
    v_add_lshl_u32 v42, v42, v50, 4
    v_lshl_or_b32 v18, v18, 7, v10
    ds_write_b64 v42, v[32:33] offset:10240
    ds_write_b32 v42, v18 offset:10248
    v_add_lshl_u32 v43, v43, v51, 4
    v_lshl_or_b32 v19, v19, 7, v11
    ds_write_b64 v43, v[34:35] offset:10240
    ds_write_b32 v43, v19 offset:10248
    s_mov_b64 exec, -1
    s_mov_b32 s4, 0x0000bf80
    s_mov_b32 s5, 0xbf800000
    s_mov_b32 s6, 0xffffff80
    s_mov_b32 s7, 3072
    s_mov_b32 s8, 2048
    s_mov_b32 s9, 1024
    s_mov_b32 s16, 0
    s_mov_b32 s17, -1
    v_mul_u32_u24 v2, 12, v0
    v_add_u32 v244, 140288, v239
    v_lshl_add_u32 v239, v79, 10, v239
    s_lshl_b32 s63, s54, 6
    s_add_u32 s63, s63, 115712
    v_add_u32 v240, s63, v239
    s_lshl_b32 s64, s53, 11
    v_add_u32 v243, s64, v240
    s_waitcnt lgkmcnt(0)
    s_barrier
    ds_read_b96 v[4:6], v82 offset:10240
    ds_read_b96 v[8:10], v82 offset:18432
    ds_read_b96 v[12:14], v82 offset:26624
    ds_read_b96 v[16:18], v82 offset:34816
    ds_read_b96 v[20:22], v82 offset:43008
    ds_read_b96 v[24:26], v82 offset:51200
    ds_read_b96 v[28:30], v82 offset:59392
    s_mov_b32 s3, 0
    s_waitcnt lgkmcnt(6)
    buffer_store_dwordx3 v[4:6], v2, s[72:75], s3 offen sc1
    s_mov_b32 s3, 6144
    s_waitcnt lgkmcnt(5)
    buffer_store_dwordx3 v[8:10], v2, s[72:75], s3 offen sc1
    s_mov_b32 s3, 12288
    s_waitcnt lgkmcnt(4)
    buffer_store_dwordx3 v[12:14], v2, s[72:75], s3 offen sc1
    s_mov_b32 s3, 18432
    s_waitcnt lgkmcnt(3)
    buffer_store_dwordx3 v[16:18], v2, s[72:75], s3 offen sc1
    s_mov_b32 s3, 24576
    s_waitcnt lgkmcnt(2)
    buffer_store_dwordx3 v[20:22], v2, s[72:75], s3 offen sc1
    s_mov_b32 s3, 30720
    s_waitcnt lgkmcnt(1)
    buffer_store_dwordx3 v[24:26], v2, s[72:75], s3 offen sc1
    s_mov_b32 s3, 36864
    s_waitcnt lgkmcnt(0)
    buffer_store_dwordx3 v[28:30], v2, s[72:75], s3 offen sc1
    v_lshlrev_b32 v61, 2, v1
    s_cmp_lg_u32 s52, 0
    s_cbranch_scc1 L_nodbg
    buffer_load_dword v60, v61, s[76:79], 0 offen sc1
L_nodbg:
    s_lshl_b32 s63, s53, 12
    s_add_u32 s63, s63, 61440
    v_lshlrev_b32 v2, 7, v78
    v_add_u32 v2, s63, v2
    v_bfe_u32 v3, v78, 1, 3
    v_xor_b32 v243, v3, v79
    v_xor_b32 v180, 0, v243
    v_lshl_add_u32 v180, v180, 4, v2
    v_xor_b32 v181, 2, v243
    v_lshl_add_u32 v181, v181, 4, v2
    v_xor_b32 v182, 4, v243
    v_lshl_add_u32 v182, v182, 4, v2
    v_xor_b32 v183, 6, v243
    v_lshl_add_u32 v183, v183, 4, v2
    s_lshl_b32 s63, s54, 2
    v_xor_b32 v243, s63, v3
    v_lshl_add_u32 v2, v79, 3, v2
    v_xor_b32 v184, 0, v243
    v_lshl_add_u32 v184, v184, 4, v2
    v_xor_b32 v185, 1, v243
    v_lshl_add_u32 v185, v185, 4, v2
    v_xor_b32 v186, 2, v243
    v_lshl_add_u32 v186, v186, 4, v2
    v_xor_b32 v187, 3, v243
    v_lshl_add_u32 v187, v187, 4, v2
    s_mul_i32 s63, s53, 4608
    s_lshl_b32 s64, s54, 6
    s_add_u32 s63, s63, s64
    v_mul_u32_u24 v2, 144, v78
    v_lshl_add_u32 v2, v79, 3, v2
    v_add_u32 v188, s63, v2
    s_mul_i32 s63, s52, 2304
    v_lshrrev_b32 v2, 3, v1
    v_mul_u32_u24 v2, 144, v2
    v_and_b32 v3, 7, v1
    v_lshl_add_u32 v2, v3, 4, v2
    v_add_u32 v189, s63, v2
    s_lshl_b32 s63, s57, 7
    s_add_u32 s63, s63, 11010048
    s_add_u32 s80, s24, s63
    s_addc_u32 s81, s25, 0
    s_mov_b32 s82, s46
    s_mov_b32 s83, 0x00020000
    s_lshl_b32 s3, s52, 11
    s_waitcnt vmcnt(7)
    s_barrier
    ds_read_b128 v[116:119], v180
    ds_read_b64_tr_b16 v[148:149], v240 offset:16384
    ds_read_b64_tr_b16 v[150:151], v240 offset:16896
    ds_read_b128 v[120:123], v181
    ds_read_b64_tr_b16 v[152:153], v240 offset:18432
    ds_read_b64_tr_b16 v[154:155], v240 offset:18944
    ds_read_b128 v[124:127], v182
    ds_read_b64_tr_b16 v[156:157], v240 offset:20480
    ds_read_b64_tr_b16 v[158:159], v240 offset:20992
    ds_read_b128 v[128:131], v183
    ds_read_b64_tr_b16 v[160:161], v240 offset:22528
    ds_read_b64_tr_b16 v[162:163], v240 offset:23040
    s_waitcnt lgkmcnt(9)
    v_mfma_f32_32x32x16_bf16 v[132:147], v[148:151], v[116:119], 0
    s_waitcnt lgkmcnt(6)
    v_mfma_f32_32x32x16_bf16 v[132:147], v[152:155], v[120:123], v[132:147]
    s_waitcnt lgkmcnt(3)
    v_mfma_f32_32x32x16_bf16 v[132:147], v[156:159], v[124:127], v[132:147]
    s_waitcnt lgkmcnt(0)
    v_mfma_f32_32x32x16_bf16 v[132:147], v[160:163], v[128:131], v[132:147]
    ds_read_b64_tr_b16 v[84:85], v244 offset:128
    ds_read_b64_tr_b16 v[86:87], v244 offset:0
    ds_read_b64_tr_b16 v[88:89], v244 offset:192
    ds_read_b64_tr_b16 v[90:91], v244 offset:64
    ds_read_b64 v[204:205], v184
    ds_read_b64 v[206:207], v185
    ds_read_b64 v[208:209], v186
    ds_read_b64 v[210:211], v187
    s_nop 3
    v_pk_mul_f32 v[132:133], v[132:133], s[58:59]
    v_pk_mul_f32 v[134:135], v[134:135], s[58:59]
    v_cvt_pk_bf16_f32 v132, v132, v133
    v_cvt_pk_bf16_f32 v133, v134, v135
    ds_write_b64 v188, v[132:133] offset:10240
    v_pk_mul_f32 v[136:137], v[136:137], s[58:59]
    v_pk_mul_f32 v[138:139], v[138:139], s[58:59]
    v_cvt_pk_bf16_f32 v136, v136, v137
    v_cvt_pk_bf16_f32 v137, v138, v139
    ds_write_b64 v188, v[136:137] offset:10256
    v_pk_mul_f32 v[140:141], v[140:141], s[58:59]
    v_pk_mul_f32 v[142:143], v[142:143], s[58:59]
    v_cvt_pk_bf16_f32 v140, v140, v141
    v_cvt_pk_bf16_f32 v141, v142, v143
    ds_write_b64 v188, v[140:141] offset:10272
    v_pk_mul_f32 v[144:145], v[144:145], s[58:59]
    v_pk_mul_f32 v[146:147], v[146:147], s[58:59]
    v_cvt_pk_bf16_f32 v144, v144, v145
    v_cvt_pk_bf16_f32 v145, v146, v147
    ds_write_b64 v188, v[144:145] offset:10288
    s_waitcnt lgkmcnt(0)
    s_barrier
    ds_read_b128 v[68:71], v189 offset:10240
    ds_read_b128 v[72:75], v189 offset:11392
    s_waitcnt lgkmcnt(1)
    buffer_store_dwordx4 v[68:71], v83, s[80:83], s3 offen sc1
    s_waitcnt lgkmcnt(0)
    buffer_store_dwordx4 v[72:75], v83, s[80:83], s3 offen offset:1024 sc1
    ds_read_b64_tr_b16 v[164:165], v240 offset:8192
    ds_read_b64_tr_b16 v[166:167], v240 offset:8704
    ds_read_b64_tr_b16 v[168:169], v240 offset:10240
    ds_read_b64_tr_b16 v[170:171], v240 offset:10752
    ds_read_b64_tr_b16 v[172:173], v240 offset:12288
    ds_read_b64_tr_b16 v[174:175], v240 offset:12800
    ds_read_b64_tr_b16 v[176:177], v240 offset:14336
    ds_read_b64_tr_b16 v[178:179], v240 offset:14848
    v_alignbit_b32 v216, v213, v212, v214
    v_lshrrev_b32 v217, v214, v213
    v_and_b32 v217, 0xffff, v217
    v_add_u32 v3, s57, v0
    v_cmp_gt_u32 vcc, 98, v0
    s_and_saveexec_b64 s[62:63], vcc
    buffer_store_dwordx2 v[216:217], v3, s[32:35], 0 idxen sc1
    s_mov_b64 exec, -1
    v_and_b32 v2, 1, v0
    v_lshlrev_b32 v2, 4, v2
    v_mov_b32 v3, 0x3f80
    v_lshlrev_b32 v2, v2, v3
    v_bfe_u32 v3, v0, 1, 2
    v_cmp_eq_u32 vcc, 0, v3
    s_nop 1
    v_cndmask_b32 v92, 0, v2, vcc
    v_cmp_eq_u32 vcc, 1, v3
    s_nop 1
    v_cndmask_b32 v93, 0, v2, vcc
    v_cmp_eq_u32 vcc, 2, v3
    s_nop 1
    v_cndmask_b32 v94, 0, v2, vcc
    v_cmp_eq_u32 vcc, 3, v3
    s_nop 1
    v_cndmask_b32 v95, 0, v2, vcc
    v_lshlrev_b32 v96, 16, v216
    v_and_b32 v97, 0xffff0000, v216
    v_lshlrev_b32 v98, 16, v217
    v_and_b32 v3, 7, v0
    v_lshlrev_b32 v99, 3, v3
    v_lshlrev_b32 v215, 16, v215
    v_mul_f32 v215, 0xbf317218, v215
    v_lshlrev_b32 v3, 2, v1
    v_add_u32 v3, 146176, v3
    s_cmp_lg_u32 s52, 4
    s_cbranch_scc1 L_nowx
    ds_write_b32 v3, v215
L_nowx:
    s_cmp_ge_u32 s52, 4
    s_cbranch_scc1 L_nont
    ds_write_b128 v81, v[92:95]
    ds_write_b128 v81, v[96:99] offset:16
L_nont:
    v_lshlrev_b32 v70, 16, v84
    v_and_b32 v71, 0xffff0000, v84
    v_lshlrev_b32 v72, 16, v85
    v_and_b32 v73, 0xffff0000, v85
    v_lshlrev_b32 v74, 16, v86
    v_pk_mul_f32 v[70:71], v[70:71], s[58:59]
    v_pk_mul_f32 v[72:73], v[72:73], s[58:59]
    v_mul_f32 v74, s58, v74
    v_cvt_pk_bf16_f32 v108, v70, v71
    v_cvt_pk_bf16_f32 v109, v72, v73
    v_cvt_pk_bf16_f32 v75, v74, v74
    v_lshlrev_b32 v75, 16, v75
    v_sub_f32 v75, v74, v75
    v_cvt_pk_bf16_f32 v110, v74, v75
    v_mov_b32 v111, 0
    v_lshlrev_b32 v70, 16, v88
    v_and_b32 v71, 0xffff0000, v88
    v_lshlrev_b32 v72, 16, v89
    v_and_b32 v73, 0xffff0000, v89
    v_lshlrev_b32 v74, 16, v90
    v_pk_mul_f32 v[70:71], v[70:71], s[58:59]
    v_pk_mul_f32 v[72:73], v[72:73], s[58:59]
    v_mul_f32 v74, s58, v74
    v_cvt_pk_bf16_f32 v112, v70, v71
    v_cvt_pk_bf16_f32 v113, v72, v73
    v_cvt_pk_bf16_f32 v75, v74, v74
    v_lshlrev_b32 v75, 16, v75
    v_sub_f32 v75, v74, v75
    v_cvt_pk_bf16_f32 v114, v74, v75
    v_mov_b32 v115, 0
    v_lshrrev_b32 v2, 3, v78
    v_sub_u32 v2, v2, v79
    v_cmp_eq_u32 vcc, 0, v2
    s_nop 1
    v_cndmask_b32 v100, 0, v92, vcc
    v_cndmask_b32 v101, 0, v93, vcc
    v_cndmask_b32 v102, 0, v94, vcc
    v_cndmask_b32 v103, 0, v95, vcc
    v_cmp_eq_u32 vcc, 2, v2
    s_nop 1
    v_cndmask_b32 v104, 0, v92, vcc
    v_cndmask_b32 v105, 0, v93, vcc
    v_cndmask_b32 v106, 0, v94, vcc
    v_cndmask_b32 v107, 0, v95, vcc
    s_lshl_b32 s3, s2, 10
    s_mov_b32 s63, 0x01010101
    s_waitcnt vmcnt(0) lgkmcnt(0)
    s_cmp_lg_u32 s52, 0
    s_cbranch_scc1 L_chkd
L_chk:
    v_cmp_ne_u32 vcc, s63, v60
    s_cbranch_vccz L_chkd
    s_sub_u32 s67, s67, 1
    s_cbranch_scc1 L_chkd
    s_sleep 8
    buffer_load_dword v60, v61, s[76:79], 0 offen sc1
    s_waitcnt vmcnt(0)
    s_branch L_chk
L_chkd:
    s_barrier
    s_cmp_lg_u32 s52, 0
    s_cbranch_scc1 L_nopub
    buffer_store_dwordx4 v[64:67], v83, s[40:43], s3 offen sc1
L_nopub:
    s_mov_b32 s63, s55
    buffer_load_dword v148, v234, s[40:43], s63 offen sc1
    s_add_u32 s63, s63, 32768
    buffer_load_dword v149, v234, s[40:43], s63 offen sc1
    s_add_u32 s63, s63, 32768
    buffer_load_dword v150, v234, s[40:43], s63 offen sc1
    s_add_u32 s63, s63, 32768
    buffer_load_dword v151, v234, s[40:43], s63 offen sc1
    s_add_u32 s63, s63, 32768
    buffer_load_dword v152, v234, s[40:43], s63 offen sc1
    s_add_u32 s63, s63, 32768
    buffer_load_dword v153, v234, s[40:43], s63 offen sc1
    s_add_u32 s63, s63, 32768
    buffer_load_dword v154, v234, s[40:43], s63 offen sc1
    s_add_u32 s63, s63, 32768
    buffer_load_dword v155, v234, s[40:43], s63 offen sc1
    v_mfma_f32_32x32x16_bf16 v[132:147], v[116:119], v[164:167], 0
    v_mfma_f32_32x32x16_bf16 v[132:147], v[120:123], v[168:171], v[132:147]
    v_mfma_f32_32x32x16_bf16 v[132:147], v[124:127], v[172:175], v[132:147]
    v_mfma_f32_32x32x16_bf16 v[132:147], v[128:131], v[176:179], v[132:147]
    s_nop 3
    s_lshl_b32 s63, s53, 12
    s_lshl_b32 s64, s54, 9
    s_add_u32 s63, s63, s64
    s_add_u32 s63, s63, 102400
    v_lshlrev_b32 v2, 4, v78
    v_lshl_add_u32 v2, v79, 3, v2
    v_add_u32 v2, s63, v2
    s_nop 0
    v_pk_mul_f32 v[132:133], v[132:133], s[58:59]
    v_pk_mul_f32 v[134:135], v[134:135], s[58:59]
    v_cvt_pk_bf16_f32 v132, v132, v133
    v_cvt_pk_bf16_f32 v133, v134, v135
    ds_write_b64 v2, v[132:133] offset:0
    s_cmp_eq_u32 s53, 3
    s_cbranch_scc1 L_at_done
    v_pk_mul_f32 v[136:137], v[136:137], s[58:59]
    v_pk_mul_f32 v[138:139], v[138:139], s[58:59]
    v_cvt_pk_bf16_f32 v136, v136, v137
    v_cvt_pk_bf16_f32 v137, v138, v139
    ds_write_b64 v2, v[136:137] offset:1024
    v_pk_mul_f32 v[140:141], v[140:141], s[58:59]
    v_pk_mul_f32 v[142:143], v[142:143], s[58:59]
    v_cvt_pk_bf16_f32 v140, v140, v141
    v_cvt_pk_bf16_f32 v141, v142, v143
    ds_write_b64 v2, v[140:141] offset:2048
    v_pk_mul_f32 v[144:145], v[144:145], s[58:59]
    v_pk_mul_f32 v[146:147], v[146:147], s[58:59]
    v_cvt_pk_bf16_f32 v144, v144, v145
    v_cvt_pk_bf16_f32 v145, v146, v147
    ds_write_b64 v2, v[144:145] offset:3072
L_at_done:
    v_mov_b32 v135, 0
    v_lshlrev_b32 v196, 16, v204
    v_and_b32 v197, 0xffff0000, v204
    v_lshlrev_b32 v198, 16, v205
    v_and_b32 v199, 0xffff0000, v205
    v_lshlrev_b32 v200, 16, v206
    v_and_b32 v201, 0xffff0000, v206
    v_lshlrev_b32 v202, 16, v207
    v_and_b32 v203, 0xffff0000, v207
    v_lshlrev_b32 v204, 16, v208
    v_and_b32 v205, 0xffff0000, v208
    v_lshlrev_b32 v206, 16, v209
    v_and_b32 v207, 0xffff0000, v209
    v_lshlrev_b32 v208, 16, v210
    v_and_b32 v209, 0xffff0000, v210
    v_lshlrev_b32 v210, 16, v211
    v_and_b32 v211, 0xffff0000, v211
    v_mov_b64 v[138:139], 0
    v_mov_b64 v[140:141], 0
    v_mov_b64 v[142:143], 0
    v_add_u32 v252, 30848, v240
    s_mul_i32 s63, s53, 8704
    s_add_u32 s63, s63, 115712
    v_mul_u32_u24 v2, 272, v78
    v_lshl_add_u32 v2, v79, 5, v2
    v_add_u32 v246, s63, v2
    v_min_u32 v3, 311, v0
    v_mul_u32_u24 v243, 171, v3
    v_lshrrev_b32 v243, 9, v243
    v_mul_u32_u24 v244, 3, v243
    v_sub_u32 v244, v3, v244
    v_lshlrev_b32 v244, 2, v244
    v_lshl_add_u32 v247, v243, 5, v244
    v_mul_u32_u24 v248, 272, v243
    v_add_u32 v248, v248, v244
    v_add_u32 v248, 115968, v248
    s_lshl_b32 s63, s52, 12
    s_add_u32 s63, s63, 53248
    v_mul_u32_u24 v2, 80, v78
    v_lshl_add_u32 v2, v79, 3, v2
    v_add_u32 v249, s63, v2
    v_lshrrev_b32 v3, 2, v1
    v_and_b32 v243, 3, v1
    v_lshlrev_b32 v243, 4, v243
    v_lshl_add_u32 v244, v3, 7, v243
    v_mul_u32_u24 v3, 80, v3
    v_add3_u32 v250, v3, v243, s63
    s_lshl_b32 s63, s53, 12
    s_lshl_b32 s64, s54, 6
    s_add_u32 s63, s63, s64
    v_add_u32 v251, s63, v244
    v_lshlrev_b32 v245, 1, v0
    v_lshrrev_b32 v3, 4, v1
    v_mul_u32_u24 v3, 272, v3
    v_and_b32 v243, 15, v1
    v_lshl_add_u32 v253, v243, 4, v3
    s_waitcnt vmcnt(7)
L_w0:
    v_cmp_le_i32 vcc, 0, v148
    s_cbranch_vccz L_g0
    s_sub_u32 s67, s67, 1
    s_cbranch_scc1 L_g0
    s_sleep 2
    s_add_u32 s63, s55, 0
    buffer_load_dword v148, v234, s[40:43], s63 offen sc1
    s_add_u32 s63, s55, 32768
    buffer_load_dword v149, v234, s[40:43], s63 offen sc1
    s_add_u32 s63, s55, 65536
    buffer_load_dword v150, v234, s[40:43], s63 offen sc1
    s_add_u32 s63, s55, 98304
    buffer_load_dword v151, v234, s[40:43], s63 offen sc1
    s_add_u32 s63, s55, 131072
    buffer_load_dword v152, v234, s[40:43], s63 offen sc1
    s_add_u32 s63, s55, 163840
    buffer_load_dword v153, v234, s[40:43], s63 offen sc1
    s_add_u32 s63, s55, 196608
    buffer_load_dword v154, v234, s[40:43], s63 offen sc1
    s_add_u32 s63, s55, 229376
    buffer_load_dword v155, v234, s[40:43], s63 offen sc1
    s_waitcnt vmcnt(0)
    s_branch L_w0
L_g0:
    v_cmp_lt_u32_sdwa s[70:71], v242, v148 src0_sel:DWORD src1_sel:WORD_1
    v_cmp_lt_u32_sdwa s[86:87], v229, v148 src0_sel:DWORD src1_sel:WORD_1
    v_max_u32 v241, v241, v148
    v_add_u32_sdwa v164, v228, v148 dst_sel:DWORD dst_unused:UNUSED_PAD src0_sel:DWORD src1_sel:WORD_0
    s_mov_b32 s63, 0
    s_mov_b64 exec, s[70:71]
    buffer_load_dwordx3 v[4:6], v164, s[36:39], s63 offen sc1
    s_mov_b64 exec, s[86:87]
    buffer_load_dwordx3 v[36:38], v164, s[36:39], s63 offen offset:192 sc1
    s_mov_b64 exec, -1
    s_waitcnt vmcnt(8)
L_w1:
    v_cmp_le_i32 vcc, 0, v149
    s_cbranch_vccz L_g1
    s_sub_u32 s67, s67, 1
    s_cbranch_scc1 L_g1
    s_sleep 2
    s_add_u32 s63, s55, 32768
    buffer_load_dword v149, v234, s[40:43], s63 offen sc1
    s_add_u32 s63, s55, 65536
    buffer_load_dword v150, v234, s[40:43], s63 offen sc1
    s_add_u32 s63, s55, 98304
    buffer_load_dword v151, v234, s[40:43], s63 offen sc1
    s_add_u32 s63, s55, 131072
    buffer_load_dword v152, v234, s[40:43], s63 offen sc1
    s_add_u32 s63, s55, 163840
    buffer_load_dword v153, v234, s[40:43], s63 offen sc1
    s_add_u32 s63, s55, 196608
    buffer_load_dword v154, v234, s[40:43], s63 offen sc1
    s_add_u32 s63, s55, 229376
    buffer_load_dword v155, v234, s[40:43], s63 offen sc1
    s_waitcnt vmcnt(0)
    s_branch L_w1
L_g1:
    v_cmp_lt_u32_sdwa s[72:73], v242, v149 src0_sel:DWORD src1_sel:WORD_1
    v_cmp_lt_u32_sdwa s[88:89], v229, v149 src0_sel:DWORD src1_sel:WORD_1
    v_max_u32 v241, v241, v149
    v_add_u32_sdwa v165, v228, v149 dst_sel:DWORD dst_unused:UNUSED_PAD src0_sel:DWORD src1_sel:WORD_0
    s_mov_b32 s63, 1204224
    s_mov_b64 exec, s[72:73]
    buffer_load_dwordx3 v[8:10], v165, s[36:39], s63 offen sc1
    s_mov_b64 exec, s[88:89]
    buffer_load_dwordx3 v[40:42], v165, s[36:39], s63 offen offset:192 sc1
    s_mov_b64 exec, -1
    s_waitcnt vmcnt(9)
L_w2:
    v_cmp_le_i32 vcc, 0, v150
    s_cbranch_vccz L_g2
    s_sub_u32 s67, s67, 1
    s_cbranch_scc1 L_g2
    s_sleep 2
    s_add_u32 s63, s55, 65536
    buffer_load_dword v150, v234, s[40:43], s63 offen sc1
    s_add_u32 s63, s55, 98304
    buffer_load_dword v151, v234, s[40:43], s63 offen sc1
    s_add_u32 s63, s55, 131072
    buffer_load_dword v152, v234, s[40:43], s63 offen sc1
    s_add_u32 s63, s55, 163840
    buffer_load_dword v153, v234, s[40:43], s63 offen sc1
    s_add_u32 s63, s55, 196608
    buffer_load_dword v154, v234, s[40:43], s63 offen sc1
    s_add_u32 s63, s55, 229376
    buffer_load_dword v155, v234, s[40:43], s63 offen sc1
    s_waitcnt vmcnt(0)
    s_branch L_w2
L_g2:
    v_cmp_lt_u32_sdwa s[74:75], v242, v150 src0_sel:DWORD src1_sel:WORD_1
    v_cmp_lt_u32_sdwa s[90:91], v229, v150 src0_sel:DWORD src1_sel:WORD_1
    v_max_u32 v241, v241, v150
    v_add_u32_sdwa v166, v228, v150 dst_sel:DWORD dst_unused:UNUSED_PAD src0_sel:DWORD src1_sel:WORD_0
    s_mov_b32 s63, 2408448
    s_mov_b64 exec, s[74:75]
    buffer_load_dwordx3 v[12:14], v166, s[36:39], s63 offen sc1
    s_mov_b64 exec, s[90:91]
    buffer_load_dwordx3 v[44:46], v166, s[36:39], s63 offen offset:192 sc1
    s_mov_b64 exec, -1
    s_waitcnt vmcnt(10)
L_w3:
    v_cmp_le_i32 vcc, 0, v151
    s_cbranch_vccz L_g3
    s_sub_u32 s67, s67, 1
    s_cbranch_scc1 L_g3
    s_sleep 2
    s_add_u32 s63, s55, 98304
    buffer_load_dword v151, v234, s[40:43], s63 offen sc1
    s_add_u32 s63, s55, 131072
    buffer_load_dword v152, v234, s[40:43], s63 offen sc1
    s_add_u32 s63, s55, 163840
    buffer_load_dword v153, v234, s[40:43], s63 offen sc1
    s_add_u32 s63, s55, 196608
    buffer_load_dword v154, v234, s[40:43], s63 offen sc1
    s_add_u32 s63, s55, 229376
    buffer_load_dword v155, v234, s[40:43], s63 offen sc1
    s_waitcnt vmcnt(0)
    s_branch L_w3
L_g3:
    v_cmp_lt_u32_sdwa s[76:77], v242, v151 src0_sel:DWORD src1_sel:WORD_1
    v_cmp_lt_u32_sdwa s[92:93], v229, v151 src0_sel:DWORD src1_sel:WORD_1
    v_max_u32 v241, v241, v151
    v_add_u32_sdwa v167, v228, v151 dst_sel:DWORD dst_unused:UNUSED_PAD src0_sel:DWORD src1_sel:WORD_0
    s_mov_b32 s63, 3612672
    s_mov_b64 exec, s[76:77]
    buffer_load_dwordx3 v[16:18], v167, s[36:39], s63 offen sc1
    s_mov_b64 exec, s[92:93]
    buffer_load_dwordx3 v[48:50], v167, s[36:39], s63 offen offset:192 sc1
    s_mov_b64 exec, -1
    s_waitcnt vmcnt(11)
L_w4:
    v_cmp_le_i32 vcc, 0, v152
    s_cbranch_vccz L_g4
    s_sub_u32 s67, s67, 1
    s_cbranch_scc1 L_g4
    s_sleep 2
    s_add_u32 s63, s55, 131072
    buffer_load_dword v152, v234, s[40:43], s63 offen sc1
    s_add_u32 s63, s55, 163840
    buffer_load_dword v153, v234, s[40:43], s63 offen sc1
    s_add_u32 s63, s55, 196608
    buffer_load_dword v154, v234, s[40:43], s63 offen sc1
    s_add_u32 s63, s55, 229376
    buffer_load_dword v155, v234, s[40:43], s63 offen sc1
    s_waitcnt vmcnt(0)
    s_branch L_w4
L_g4:
    v_cmp_lt_u32_sdwa s[78:79], v242, v152 src0_sel:DWORD src1_sel:WORD_1
    v_cmp_lt_u32_sdwa s[94:95], v229, v152 src0_sel:DWORD src1_sel:WORD_1
    v_max_u32 v241, v241, v152
    v_add_u32_sdwa v168, v228, v152 dst_sel:DWORD dst_unused:UNUSED_PAD src0_sel:DWORD src1_sel:WORD_0
    s_mov_b32 s63, 4816896
    s_mov_b64 exec, s[78:79]
    buffer_load_dwordx3 v[20:22], v168, s[36:39], s63 offen sc1
    s_mov_b64 exec, s[94:95]
    buffer_load_dwordx3 v[52:54], v168, s[36:39], s63 offen offset:192 sc1
    s_mov_b64 exec, -1
    s_waitcnt vmcnt(12)
L_w5:
    v_cmp_le_i32 vcc, 0, v153
    s_cbranch_vccz L_g5
    s_sub_u32 s67, s67, 1
    s_cbranch_scc1 L_g5
    s_sleep 2
    s_add_u32 s63, s55, 163840
    buffer_load_dword v153, v234, s[40:43], s63 offen sc1
    s_add_u32 s63, s55, 196608
    buffer_load_dword v154, v234, s[40:43], s63 offen sc1
    s_add_u32 s63, s55, 229376
    buffer_load_dword v155, v234, s[40:43], s63 offen sc1
    s_waitcnt vmcnt(0)
    s_branch L_w5
L_g5:
    v_cmp_lt_u32_sdwa s[80:81], v242, v153 src0_sel:DWORD src1_sel:WORD_1
    v_cmp_lt_u32_sdwa s[96:97], v229, v153 src0_sel:DWORD src1_sel:WORD_1
    v_max_u32 v241, v241, v153
    v_add_u32_sdwa v169, v228, v153 dst_sel:DWORD dst_unused:UNUSED_PAD src0_sel:DWORD src1_sel:WORD_0
    s_mov_b32 s63, 6021120
    s_mov_b64 exec, s[80:81]
    buffer_load_dwordx3 v[24:26], v169, s[36:39], s63 offen sc1
    s_mov_b64 exec, s[96:97]
    buffer_load_dwordx3 v[56:58], v169, s[36:39], s63 offen offset:192 sc1
    s_mov_b64 exec, -1
    s_waitcnt vmcnt(13)
L_w6:
    v_cmp_le_i32 vcc, 0, v154
    s_cbranch_vccz L_g6
    s_sub_u32 s67, s67, 1
    s_cbranch_scc1 L_g6
    s_sleep 2
    s_add_u32 s63, s55, 196608
    buffer_load_dword v154, v234, s[40:43], s63 offen sc1
    s_add_u32 s63, s55, 229376
    buffer_load_dword v155, v234, s[40:43], s63 offen sc1
    s_waitcnt vmcnt(0)
    s_branch L_w6
L_g6:
    v_cmp_lt_u32_sdwa s[82:83], v242, v154 src0_sel:DWORD src1_sel:WORD_1
    v_cmp_lt_u32_sdwa s[98:99], v229, v154 src0_sel:DWORD src1_sel:WORD_1
    v_max_u32 v241, v241, v154
    v_add_u32_sdwa v170, v228, v154 dst_sel:DWORD dst_unused:UNUSED_PAD src0_sel:DWORD src1_sel:WORD_0
    s_mov_b32 s63, 7225344
    s_mov_b64 exec, s[82:83]
    buffer_load_dwordx3 v[28:30], v170, s[36:39], s63 offen sc1
    s_mov_b64 exec, s[98:99]
    buffer_load_dwordx3 v[60:62], v170, s[36:39], s63 offen offset:192 sc1
    s_mov_b64 exec, -1
    s_waitcnt vmcnt(14)
L_w7:
    v_cmp_le_i32 vcc, 0, v155
    s_cbranch_vccz L_g7
    s_sub_u32 s67, s67, 1
    s_cbranch_scc1 L_g7
    s_sleep 2
    s_add_u32 s63, s55, 229376
    buffer_load_dword v155, v234, s[40:43], s63 offen sc1
    s_waitcnt vmcnt(0)
    s_branch L_w7
L_g7:
    v_cmp_lt_u32_sdwa s[84:85], v242, v155 src0_sel:DWORD src1_sel:WORD_1
    v_cmp_lt_u32_sdwa s[100:101], v229, v155 src0_sel:DWORD src1_sel:WORD_1
    v_max_u32 v241, v241, v155
    v_add_u32_sdwa v171, v228, v155 dst_sel:DWORD dst_unused:UNUSED_PAD src0_sel:DWORD src1_sel:WORD_0
    s_mov_b32 s63, 8429568
    s_mov_b64 exec, s[84:85]
    buffer_load_dwordx3 v[32:34], v171, s[36:39], s63 offen sc1
    s_mov_b64 exec, s[100:101]
    buffer_load_dwordx3 v[64:66], v171, s[36:39], s63 offen offset:192 sc1
    s_mov_b64 exec, -1
    v_cmp_lt_u32 vcc, 0x8020ffff, v241
    s_and_saveexec_b64 s[62:63], vcc
    v_mov_b32 v2, 146432
    ds_write_b32 v2, v218
    s_mov_b64 exec, -1
L_rank:
    s_waitcnt vmcnt(14)
    s_mov_b64 exec, s[70:71]
    v_lshlrev_b32_sdwa v164, 2, v6 dst_sel:DWORD dst_unused:UNUSED_PAD src0_sel:DWORD src1_sel:BYTE_0
    ds_add_rtn_u32 v7, v164, v218 offset:8192
    s_cmp_eq_u64 s[86:87], 0
    s_cbranch_scc1 L_rk8
    s_mov_b64 exec, s[86:87]
    v_lshlrev_b32_sdwa v172, 2, v38 dst_sel:DWORD dst_unused:UNUSED_PAD src0_sel:DWORD src1_sel:BYTE_0
    ds_add_rtn_u32 v39, v172, v218 offset:8192
L_rk8:
    s_waitcnt vmcnt(12)
    s_mov_b64 exec, s[72:73]
    v_lshlrev_b32_sdwa v165, 2, v10 dst_sel:DWORD dst_unused:UNUSED_PAD src0_sel:DWORD src1_sel:BYTE_0
    ds_add_rtn_u32 v11, v165, v218 offset:8192
    s_cmp_eq_u64 s[88:89], 0
    s_cbranch_scc1 L_rk9
    s_mov_b64 exec, s[88:89]
    v_lshlrev_b32_sdwa v173, 2, v42 dst_sel:DWORD dst_unused:UNUSED_PAD src0_sel:DWORD src1_sel:BYTE_0
    ds_add_rtn_u32 v43, v173, v218 offset:8192
L_rk9:
    s_waitcnt vmcnt(10)
    s_mov_b64 exec, s[74:75]
    v_lshlrev_b32_sdwa v166, 2, v14 dst_sel:DWORD dst_unused:UNUSED_PAD src0_sel:DWORD src1_sel:BYTE_0
    ds_add_rtn_u32 v15, v166, v218 offset:8192
    s_cmp_eq_u64 s[90:91], 0
    s_cbranch_scc1 L_rk10
    s_mov_b64 exec, s[90:91]
    v_lshlrev_b32_sdwa v174, 2, v46 dst_sel:DWORD dst_unused:UNUSED_PAD src0_sel:DWORD src1_sel:BYTE_0
    ds_add_rtn_u32 v47, v174, v218 offset:8192
L_rk10:
    s_waitcnt vmcnt(8)
    s_mov_b64 exec, s[76:77]
    v_lshlrev_b32_sdwa v167, 2, v18 dst_sel:DWORD dst_unused:UNUSED_PAD src0_sel:DWORD src1_sel:BYTE_0
    ds_add_rtn_u32 v19, v167, v218 offset:8192
    s_cmp_eq_u64 s[92:93], 0
    s_cbranch_scc1 L_rk11
    s_mov_b64 exec, s[92:93]
    v_lshlrev_b32_sdwa v175, 2, v50 dst_sel:DWORD dst_unused:UNUSED_PAD src0_sel:DWORD src1_sel:BYTE_0
    ds_add_rtn_u32 v51, v175, v218 offset:8192
L_rk11:
    s_waitcnt vmcnt(6)
    s_mov_b64 exec, s[78:79]
    v_lshlrev_b32_sdwa v168, 2, v22 dst_sel:DWORD dst_unused:UNUSED_PAD src0_sel:DWORD src1_sel:BYTE_0
    ds_add_rtn_u32 v23, v168, v218 offset:8192
    s_cmp_eq_u64 s[94:95], 0
    s_cbranch_scc1 L_rk12
    s_mov_b64 exec, s[94:95]
    v_lshlrev_b32_sdwa v176, 2, v54 dst_sel:DWORD dst_unused:UNUSED_PAD src0_sel:DWORD src1_sel:BYTE_0
    ds_add_rtn_u32 v55, v176, v218 offset:8192
L_rk12:
    s_waitcnt vmcnt(4)
    s_mov_b64 exec, s[80:81]
    v_lshlrev_b32_sdwa v169, 2, v26 dst_sel:DWORD dst_unused:UNUSED_PAD src0_sel:DWORD src1_sel:BYTE_0
    ds_add_rtn_u32 v27, v169, v218 offset:8192
    s_cmp_eq_u64 s[96:97], 0
    s_cbranch_scc1 L_rk13
    s_mov_b64 exec, s[96:97]
    v_lshlrev_b32_sdwa v177, 2, v58 dst_sel:DWORD dst_unused:UNUSED_PAD src0_sel:DWORD src1_sel:BYTE_0
    ds_add_rtn_u32 v59, v177, v218 offset:8192
L_rk13:
    s_waitcnt vmcnt(2)
    s_mov_b64 exec, s[82:83]
    v_lshlrev_b32_sdwa v170, 2, v30 dst_sel:DWORD dst_unused:UNUSED_PAD src0_sel:DWORD src1_sel:BYTE_0
    ds_add_rtn_u32 v31, v170, v218 offset:8192
    s_cmp_eq_u64 s[98:99], 0
    s_cbranch_scc1 L_rk14
    s_mov_b64 exec, s[98:99]
    v_lshlrev_b32_sdwa v178, 2, v62 dst_sel:DWORD dst_unused:UNUSED_PAD src0_sel:DWORD src1_sel:BYTE_0
    ds_add_rtn_u32 v63, v178, v218 offset:8192
L_rk14:
    s_waitcnt vmcnt(0)
    s_mov_b64 exec, s[84:85]
    v_lshlrev_b32_sdwa v171, 2, v34 dst_sel:DWORD dst_unused:UNUSED_PAD src0_sel:DWORD src1_sel:BYTE_0
    ds_add_rtn_u32 v35, v171, v218 offset:8192
    s_cmp_eq_u64 s[100:101], 0
    s_cbranch_scc1 L_rk15
    s_mov_b64 exec, s[100:101]
    v_lshlrev_b32_sdwa v179, 2, v66 dst_sel:DWORD dst_unused:UNUSED_PAD src0_sel:DWORD src1_sel:BYTE_0
    ds_add_rtn_u32 v67, v179, v218 offset:8192
L_rk15:
    s_mov_b64 exec, -1
    v_lshlrev_b32 v2, 3, v1
    v_mov_b32 v3, 146432
    s_mov_b32 s15, 0
    s_cmp_lg_u32 s56, 0
    s_cselect_b32 s15, 31, s15
    s_waitcnt lgkmcnt(0)
    s_barrier
    ds_read_b64 v[148:149], v2 offset:8192
    ds_read_b64 v[150:151], v2 offset:8704
    ds_read_b32 v152, v3
    v_and_b32 v243, 3, v1
    v_cmp_eq_u32 s[10:11], 3, v243
    s_cmp_lg_u32 s56, 0
    s_cbranch_scc1 L_noaz
    s_lshl_b32 s63, s52, 10
    s_add_u32 s64, s63, 8192
    s_add_u32 m0, s63, 146560
    s_lshl_b32 s69, s52, 12
    buffer_load_dwordx4 v83, s[20:23], s63 offen lds
    s_add_u32 m0, s63, 154752
    s_nop 0
    buffer_load_dwordx4 v83, s[20:23], s64 offen lds
    s_add_u32 m0, s69, 53248
    v_add_u32 v3, 115712, v82
    ds_write_b128 v3, v[140:143] offset:0
    ds_write_b128 v3, v[140:143] offset:8192
    ds_write_b128 v3, v[140:143] offset:16384
    v_cmp_gt_u32 vcc, 368, v0
    s_and_saveexec_b64 s[62:63], vcc
    ds_write_b128 v3, v[140:143] offset:24576
    s_mov_b64 exec, -1
    s_waitcnt lgkmcnt(4)
L_azd:
    v_add_u32 v162, v148, v150
    v_add3_u32 v153, v162, v149, v151
    v_readfirstlane_b32 s69, v152
    s_nop 0
    v_add_u32_dpp v154, v153, v153 quad_perm:[1,0,3,2] row_mask:0xf bank_mask:0xf
    s_nop 1
    v_add_u32_dpp v154, v154, v154 quad_perm:[2,3,0,1] row_mask:0xf bank_mask:0xf
L_scan:
    v_sub_u32 v155, 0, v154
    v_and_b32 v155, s15, v155
    v_cndmask_b32 v155, 0, v155, s[10:11]
    v_add_u32 v161, v153, v155
    v_mov_b32 v160, v161
    s_nop 1
    v_add_u32_dpp v160, v160, v160 row_shr:1 row_mask:0xf bank_mask:0xf bound_ctrl:0
    s_nop 1
    v_add_u32_dpp v160, v160, v160 row_shr:2 row_mask:0xf bank_mask:0xf bound_ctrl:0
    s_nop 1
    v_add_u32_dpp v160, v160, v160 row_shr:4 row_mask:0xf bank_mask:0xf bound_ctrl:0
    s_nop 1
    v_add_u32_dpp v160, v160, v160 row_shr:8 row_mask:0xf bank_mask:0xf bound_ctrl:0
    s_nop 1
    v_add_u32_dpp v160, v160, v160 row_bcast:15 row_mask:0xa bank_mask:0xf
    s_nop 1
    v_add_u32_dpp v160, v160, v160 row_bcast:31 row_mask:0xc bank_mask:0xf
    s_nop 0
    v_readlane_b32 s63, v160, 63
    v_sub_u32 v156, v160, v161
    s_cmp_lg_u32 s15, 0
    s_cbranch_scc1 L_scan_pad
    v_mov_b32_dpp v155, v160 quad_perm:[1,1,3,3] row_mask:0xf bank_mask:0xf
    v_add_u32 v243, -1, v156
    v_xor_b32 v243, v243, v155
    v_cmp_gt_u32 vcc, 32, v243
    v_cmp_gt_u32 s[12:13], s63, v155
    s_and_b64 vcc, vcc, s[12:13]
    s_and_b32 vcc_lo, vcc_lo, 0x55555555
    s_and_b32 vcc_hi, vcc_hi, 0x55555555
    v_mov_b32 v155, s63
    s_cmp_eq_u64 vcc, 0
    s_cbranch_scc1 L_scan_done
    s_mov_b32 s15, 31
    s_branch L_scan
L_scan_pad:
    v_mov_b32_dpp v155, v156 quad_perm:[0,0,0,0] row_mask:0xf bank_mask:0xf
    v_add_u32 v155, v155, v154
    v_mov_b64 v[144:145], 0
    v_mov_b64 v[146:147], 0
    v_lshlrev_b32 v3, 4, v0
    ds_write_b128 v3, v[144:147] offset:10240
    ds_write_b128 v3, v[144:147] offset:18432
    ds_write_b128 v3, v[144:147] offset:26624
    ds_write_b128 v3, v[144:147] offset:34816
    ds_write_b128 v3, v[144:147] offset:43008
    ds_write_b128 v3, v[144:147] offset:51200
    s_waitcnt lgkmcnt(0)
    s_barrier
L_scan_done:
    v_lshrrev_b32 v3, 1, v1
    v_add_u32 v243, s63, v3
    v_mul_u32_u24 v243, 12, v243
    v_add_u32 v243, 10240, v243
    v_add_u32 v157, v156, v162
    v_add_u32 v158, v156, v148
    v_add_u32 v159, v157, v149
    ds_write_b64 v2, v[156:157] offset:9216
    ds_write_b64 v2, v[158:159] offset:9728
    v_and_b32 v3, 60, v1
    v_add_u32 v3, 146448, v3
    ds_write_b32 v3, v155
    s_add_u32 s63, s63, 31
    s_lshr_b32 s63, s63, 5
    s_cmp_gt_u32 s63, 112
    s_cselect_b32 s69, 1, s69
    s_cmp_lg_u32 s69, 0
    s_cbranch_scc1 L_slow
    ds_write2_b32 v243, v235, v235 offset0:0 offset1:1
    ds_write_b32 v243, v235 offset:8
    s_mov_b64 exec, s[70:71]
    ds_read_b32 v164, v164 offset:9216
    s_cmp_eq_u64 s[86:87], 0
    s_cbranch_scc1 L_pa8
    s_mov_b64 exec, s[86:87]
    ds_read_b32 v172, v172 offset:9216
L_pa8:
    s_mov_b64 exec, s[72:73]
    ds_read_b32 v165, v165 offset:9216
    s_cmp_eq_u64 s[88:89], 0
    s_cbranch_scc1 L_pa9
    s_mov_b64 exec, s[88:89]
    ds_read_b32 v173, v173 offset:9216
L_pa9:
    s_mov_b64 exec, s[74:75]
    ds_read_b32 v166, v166 offset:9216
    s_cmp_eq_u64 s[90:91], 0
    s_cbranch_scc1 L_pa10
    s_mov_b64 exec, s[90:91]
    ds_read_b32 v174, v174 offset:9216
L_pa10:
    s_mov_b64 exec, s[76:77]
    ds_read_b32 v167, v167 offset:9216
    s_cmp_eq_u64 s[92:93], 0
    s_cbranch_scc1 L_pa11
    s_mov_b64 exec, s[92:93]
    ds_read_b32 v175, v175 offset:9216
L_pa11:
    s_mov_b64 exec, s[78:79]
    ds_read_b32 v168, v168 offset:9216
    s_cmp_eq_u64 s[94:95], 0
    s_cbranch_scc1 L_pa12
    s_mov_b64 exec, s[94:95]
    ds_read_b32 v176, v176 offset:9216
L_pa12:
    s_mov_b64 exec, s[80:81]
    ds_read_b32 v169, v169 offset:9216
    s_cmp_eq_u64 s[96:97], 0
    s_cbranch_scc1 L_pa13
    s_mov_b64 exec, s[96:97]
    ds_read_b32 v177, v177 offset:9216
L_pa13:
    s_mov_b64 exec, s[82:83]
    ds_read_b32 v170, v170 offset:9216
    s_cmp_eq_u64 s[98:99], 0
    s_cbranch_scc1 L_pa14
    s_mov_b64 exec, s[98:99]
    ds_read_b32 v178, v178 offset:9216
L_pa14:
    s_mov_b64 exec, s[84:85]
    ds_read_b32 v171, v171 offset:9216
    s_cmp_eq_u64 s[100:101], 0
    s_cbranch_scc1 L_pa15
    s_mov_b64 exec, s[100:101]
    ds_read_b32 v179, v179 offset:9216
L_pa15:
    s_and_b32 s65, s52, 3
    s_mul_i32 s65, s65, s63
    s_add_u32 s66, s65, s63
    s_lshr_b32 s65, s65, 2
    s_lshr_b32 s66, s66, 2
    s_sub_u32 s63, s66, s65
    s_mul_i32 s63, s63, 44
    s_add_u32 s63, s63, 32
    s_lshr_b32 s63, s63, 6
    s_add_u32 s63, s63, s65
    s_and_b32 s18, s52, 4
    s_cmp_eq_u32 s63, s65
    s_cselect_b32 s18, 0, s18
    s_cmp_lt_u32 s52, 4
    s_cselect_b32 s66, s63, s66
    s_cselect_b32 s65, s65, s63
    s_sub_u32 s66, s66, s65
    s_mov_b32 s64, 10240
    s_waitcnt lgkmcnt(0)
    s_mov_b64 exec, s[70:71]
    v_add_u32 v164, v164, v7
    v_mad_u32_u24 v164, v164, 12, s64
    ds_write_b32 v164, v6 offset:8
    ds_write2_b32 v164, v4, v5 offset0:0 offset1:1
    s_cmp_eq_u64 s[86:87], 0
    s_cbranch_scc1 L_pb8
    s_mov_b64 exec, s[86:87]
    v_add_u32 v172, v172, v39
    v_mad_u32_u24 v172, v172, 12, s64
    ds_write_b32 v172, v38 offset:8
    ds_write2_b32 v172, v36, v37 offset0:0 offset1:1
L_pb8:
    s_mov_b64 exec, s[72:73]
    v_add_u32 v165, v165, v11
    v_mad_u32_u24 v165, v165, 12, s64
    ds_write_b32 v165, v10 offset:8
    ds_write2_b32 v165, v8, v9 offset0:0 offset1:1
    s_cmp_eq_u64 s[88:89], 0
    s_cbranch_scc1 L_pb9
    s_mov_b64 exec, s[88:89]
    v_add_u32 v173, v173, v43
    v_mad_u32_u24 v173, v173, 12, s64
    ds_write_b32 v173, v42 offset:8
    ds_write2_b32 v173, v40, v41 offset0:0 offset1:1
L_pb9:
    s_mov_b64 exec, s[74:75]
    v_add_u32 v166, v166, v15
    v_mad_u32_u24 v166, v166, 12, s64
    ds_write_b32 v166, v14 offset:8
    ds_write2_b32 v166, v12, v13 offset0:0 offset1:1
    s_cmp_eq_u64 s[90:91], 0
    s_cbranch_scc1 L_pb10
    s_mov_b64 exec, s[90:91]
    v_add_u32 v174, v174, v47
    v_mad_u32_u24 v174, v174, 12, s64
    ds_write_b32 v174, v46 offset:8
    ds_write2_b32 v174, v44, v45 offset0:0 offset1:1
L_pb10:
    s_mov_b64 exec, s[76:77]
    v_add_u32 v167, v167, v19
    v_mad_u32_u24 v167, v167, 12, s64
    ds_write_b32 v167, v18 offset:8
    ds_write2_b32 v167, v16, v17 offset0:0 offset1:1
    s_cmp_eq_u64 s[92:93], 0
    s_cbranch_scc1 L_pb11
    s_mov_b64 exec, s[92:93]
    v_add_u32 v175, v175, v51
    v_mad_u32_u24 v175, v175, 12, s64
    ds_write_b32 v175, v50 offset:8
    ds_write2_b32 v175, v48, v49 offset0:0 offset1:1
L_pb11:
    s_mov_b64 exec, s[78:79]
    v_add_u32 v168, v168, v23
    v_mad_u32_u24 v168, v168, 12, s64
    ds_write_b32 v168, v22 offset:8
    ds_write2_b32 v168, v20, v21 offset0:0 offset1:1
    s_cmp_eq_u64 s[94:95], 0
    s_cbranch_scc1 L_pb12
    s_mov_b64 exec, s[94:95]
    v_add_u32 v176, v176, v55
    v_mad_u32_u24 v176, v176, 12, s64
    ds_write_b32 v176, v54 offset:8
    ds_write2_b32 v176, v52, v53 offset0:0 offset1:1
L_pb12:
    s_mov_b64 exec, s[80:81]
    v_add_u32 v169, v169, v27
    v_mad_u32_u24 v169, v169, 12, s64
    ds_write_b32 v169, v26 offset:8
    ds_write2_b32 v169, v24, v25 offset0:0 offset1:1
    s_cmp_eq_u64 s[96:97], 0
    s_cbranch_scc1 L_pb13
    s_mov_b64 exec, s[96:97]
    v_add_u32 v177, v177, v59
    v_mad_u32_u24 v177, v177, 12, s64
    ds_write_b32 v177, v58 offset:8
    ds_write2_b32 v177, v56, v57 offset0:0 offset1:1
L_pb13:
    s_mov_b64 exec, s[82:83]
    v_add_u32 v170, v170, v31
    v_mad_u32_u24 v170, v170, 12, s64
    ds_write_b32 v170, v30 offset:8
    ds_write2_b32 v170, v28, v29 offset0:0 offset1:1
    s_cmp_eq_u64 s[98:99], 0
    s_cbranch_scc1 L_pb14
    s_mov_b64 exec, s[98:99]
    v_add_u32 v178, v178, v63
    v_mad_u32_u24 v178, v178, 12, s64
    ds_write_b32 v178, v62 offset:8
    ds_write2_b32 v178, v60, v61 offset0:0 offset1:1
L_pb14:
    s_mov_b64 exec, s[84:85]
    v_add_u32 v171, v171, v35
    v_mad_u32_u24 v171, v171, 12, s64
    ds_write_b32 v171, v34 offset:8
    ds_write2_b32 v171, v32, v33 offset0:0 offset1:1
    s_cmp_eq_u64 s[100:101], 0
    s_cbranch_scc1 L_pb15
    s_mov_b64 exec, s[100:101]
    v_add_u32 v179, v179, v67
    v_mad_u32_u24 v179, v179, 12, s64
    ds_write_b32 v179, v66 offset:8
    ds_write2_b32 v179, v64, v65 offset0:0 offset1:1
L_pb15:
    s_mov_b64 exec, -1
    s_mul_i32 s63, s65, 384
    s_add_u32 s63, s63, 10240
    v_and_b32 v2, 31, v1
    v_mul_u32_u24 v2, 12, v2
    v_add_u32 v228, s63, v2
    v_lshrrev_b32 v2, 3, v1
    v_mul_u32_u24 v2, 48, v2
    v_add_u32 v229, s63, v2
    s_sub_u32 s63, s65, 1
    v_add_u32 v3, s63, v1
    v_mul_u32_u24 v2, 384, v3
    s_waitcnt vmcnt(0) lgkmcnt(0)
    s_barrier
    s_cmp_eq_u32 s66, 0
    s_cbranch_scc1 L_idle
    ds_read_b32 v239, v228 offset:8
    ds_read2_b32 v[144:145], v229 offset0:2 offset1:5
    ds_read2_b32 v[146:147], v229 offset0:8 offset1:11
    ds_read_u8 v243, v2 offset:10248
    ds_read2_b32 v[132:133], v228 offset0:0 offset1:1
    v_mov_b64 v[36:37], 0
    v_mov_b64 v[38:39], 0
    v_mov_b64 v[40:41], 0
    v_mov_b64 v[42:43], 0
    v_mov_b64 v[44:45], 0
    v_mov_b64 v[46:47], 0
    v_mov_b64 v[48:49], 0
    v_mov_b64 v[50:51], 0
    v_mov_b64 v[52:53], 0
    v_mov_b64 v[54:55], 0
    v_mov_b64 v[56:57], 0
    v_mov_b64 v[58:59], 0
    v_mov_b64 v[60:61], 0
    v_mov_b64 v[62:63], 0
    v_mov_b64 v[64:65], 0
    v_mov_b64 v[66:67], 0
    v_mov_b64 v[156:157], 0
    v_mov_b64 v[136:137], 0
    v_mov_b64 v[158:159], 0
    v_mov_b64 v[138:139], 0
    v_mov_b64 v[160:161], 0
    v_mov_b64 v[140:141], 0
    v_mov_b64 v[162:163], 0
    v_mov_b64 v[142:143], 0
    s_waitcnt lgkmcnt(2)
    v_and_or_b32 v144, v144, s6, v224
    v_and_or_b32 v145, v145, s6, v225
    v_and_or_b32 v146, v146, s6, v226
    v_and_or_b32 v147, v147, s6, v227
    buffer_load_dwordx4 v144, s[28:31], s7 offen offset:0 lds
    buffer_load_dwordx4 v145, s[28:31], s8 offen offset:1024 lds
    buffer_load_dwordx4 v146, s[28:31], s9 offen offset:2048 lds
    buffer_load_dwordx4 v147, s[28:31], 0 offen offset:3072 lds
    v_lshrrev_b32 v240, 7, v239
    v_lshlrev_b32_sdwa v241, 5, v239 dst_sel:DWORD dst_unused:UNUSED_PAD src0_sel:DWORD src1_sel:BYTE_0
    buffer_load_dwordx2 v[216:217], v240, s[32:35], 0 idxen
    ds_read_b128 v[212:215], v241 offset:16
    ds_read_b32 v239, v228 offset:392
    ds_read2_b32 v[144:145], v229 offset0:98 offset1:101
    ds_read2_b32 v[146:147], v229 offset0:104 offset1:107
    s_waitcnt lgkmcnt(5)
    v_and_b32 v243, 0x7f, v243
    v_lshrrev_b32 v244, 3, v243
    v_lshlrev_b32 v244, 2, v244
    v_add_u32 v244, 146448, v244
    ds_read_b32 v244, v244
    v_lshlrev_b32 v3, 5, v3
    s_waitcnt lgkmcnt(0)
    v_sub_u32 v244, v244, v3
    v_min_u32 v244, 32, v244
    v_mad_u32_u24 v2, v244, 12, v2
    ds_read_u8 v2, v2 offset:10236
    v_lshl_or_b32 v243, v244, 16, v243
    s_waitcnt lgkmcnt(0)
    v_and_b32 v2, 0x7f, v2
    v_lshl_or_b32 v234, v2, 8, v243
    s_nop 0
    v_readlane_b32 s62, v234, 1
    v_readlane_b32 s13, v234, 0
    s_nop 1
    s_and_b32 s10, s62, 0x7c
    s_mov_b32 s11, s10
    s_lshr_b32 s68, s62, 16
    s_bfe_u32 s13, s13, 0x80008
    s_cmp_eq_u32 s65, 0
    s_cselect_b32 s13, -1, s13
    s_add_u32 s63, s10, 4
    s_lshr_b32 s63, s63, 3
    s_lshl_b32 s63, s63, 10
    s_lshr_b32 s64, s10, 3
    s_lshl_b32 s64, s64, 10
    v_add_u32 v2, s63, v233
    v_add_u32 v3, s64, v233
    s_mov_b64 exec, s[16:17]
    ds_read_b64 v[108:109], v2
    ds_read_b64 v[110:111], v3 offset:8
    ds_read_b64 v[112:113], v2 offset:512
    ds_read_b64 v[114:115], v3 offset:520
    s_mov_b64 exec, -1
    v_lshrrev_b32 v244, 5, v1
    v_lshlrev_b32 v244, 7, v244
    v_add_u32 v244, 146176, v244
    ds_read_b128 v[68:71], v244 offset:0
    ds_read_b128 v[72:75], v244 offset:16
    ds_read_b128 v[76:79], v244 offset:32
    ds_read_b128 v[80:83], v244 offset:48
    ds_read_b128 v[84:87], v244 offset:64
    ds_read_b128 v[88:91], v244 offset:80
    ds_read_b128 v[92:95], v244 offset:96
    ds_read_b128 v[96:99], v244 offset:112
    s_cmp_lg_u32 s56, 0
    s_cbranch_scc1 L_nou
    ds_read_b64_tr_b16 v[164:165], v252 offset:0
    ds_read_b64_tr_b16 v[166:167], v252 offset:512
    ds_read_b64_tr_b16 v[168:169], v252 offset:2048
    ds_read_b64_tr_b16 v[170:171], v252 offset:2560
    ds_read_b64_tr_b16 v[172:173], v252 offset:4096
    ds_read_b64_tr_b16 v[174:175], v252 offset:4608
    ds_read_b64_tr_b16 v[176:177], v252 offset:6144
    ds_read_b64_tr_b16 v[178:179], v252 offset:6656
    s_waitcnt lgkmcnt(0)
    v_mfma_f32_32x32x16_bf16 v[180:195], v[164:167], v[116:119], 0
    v_mfma_f32_32x32x16_bf16 v[180:195], v[168:171], v[120:123], v[180:195]
    v_mfma_f32_32x32x16_bf16 v[180:195], v[172:175], v[124:127], v[180:195]
    v_mfma_f32_32x32x16_bf16 v[180:195], v[176:179], v[128:131], v[180:195]
    s_nop 7
    s_nop 3
    v_pk_mul_f32 v[180:181], v[180:181], s[58:59]
    v_pk_mul_f32 v[182:183], v[182:183], s[58:59]
    v_pk_mul_f32 v[184:185], v[184:185], s[58:59]
    v_pk_mul_f32 v[186:187], v[186:187], s[58:59]
    v_pk_mul_f32 v[188:189], v[188:189], s[58:59]
    v_pk_mul_f32 v[190:191], v[190:191], s[58:59]
    v_pk_mul_f32 v[192:193], v[192:193], s[58:59]
    v_pk_mul_f32 v[194:195], v[194:195], s[58:59]
L_nou:
    s_waitcnt vmcnt(1)
    ds_read_b128 v[116:119], v220
    ds_read_b128 v[120:123], v221
    ds_read_b128 v[124:127], v222
    ds_read_b128 v[128:131], v223
    s_waitcnt lgkmcnt(0)
    v_and_or_b32 v144, v144, s6, v224
    v_and_or_b32 v145, v145, s6, v225
    v_and_or_b32 v146, v146, s6, v226
    v_and_or_b32 v147, v147, s6, v227
    buffer_load_dwordx4 v144, s[28:31], s7 offen offset:0 lds
    buffer_load_dwordx4 v145, s[28:31], s8 offen offset:1024 lds
    buffer_load_dwordx4 v146, s[28:31], s9 offen offset:2048 lds
    buffer_load_dwordx4 v147, s[28:31], 0 offen offset:3072 lds
    s_waitcnt vmcnt(4)
    v_dot2_f32_bf16 v2, v216, s4, v212
    v_dot2_f32_bf16 v3, v216, s5, v213
    v_dot2_f32_bf16 v243, v217, s4, v214
    v_xor_b32 v242, v230, v215
    v_lshrrev_b32 v240, 7, v239
    buffer_load_dwordx2 v[216:217], v240, s[32:35], 0 idxen
    v_cvt_pk_bf16_f32 v218, v2, v3
    v_cvt_pk_bf16_f32 v244, v243, 0
    v_cvt_pk_bf16_f32 v219, v243, 1.0
    v_dot2_f32_bf16 v2, v218, v218, 0
    v_dot2_f32_bf16 v2, v244, v244, v2
    s_nop 2
    v_cvt_pk_bf16_f32 v134, v2, v2
    s_mov_b64 exec, s[16:17]
    ds_read_b128 v[132:135], v241
    s_mov_b64 exec, -1
    v_lshlrev_b32_sdwa v241, 5, v239 dst_sel:DWORD dst_unused:UNUSED_PAD src0_sel:DWORD src1_sel:BYTE_0
    v_mfma_f32_32x32x16_bf16 v[4:19], v[116:119], v[100:103], 0
    v_mfma_f32_32x32x16_bf16 v[4:19], v[120:123], v[104:107], v[4:19]
    s_waitcnt lgkmcnt(0)
    v_mfma_f32_32x32x16_bf16 v[4:19], v[132:135], v[108:111], v[4:19]
    s_mov_b32 s67, 2
    s_add_u32 s66, s66, 1
    s_cmp_ge_u32 s52, 4
    s_cbranch_scc1 L_np
    s_setprio 1
L_np:
    s_nop 7
    s_nop 1
    .p2align 6
L_loop:
    ds_read_b32 v239, v228 offset:776
    ds_read2_b32 v[144:145], v229 offset0:194 offset1:197
    ds_read2_b32 v[146:147], v229 offset0:200 offset1:203
    ds_read_b128 v[212:215], v241 offset:16
    v_readlane_b32 s62, v234, s67
    s_bfm_b64 exec, s68, 0
    ds_write_b64 v242, v[218:219]
    s_mov_b64 exec, -1
    v_exp_f32 v164, v4
    v_exp_f32 v165, v5
    v_mfma_f32_32x32x16_bf16 v[20:35], v[124:127], v[100:103], 0
    v_exp_f32 v166, v6
    v_exp_f32 v167, v7
    v_exp_f32 v168, v8
    v_exp_f32 v169, v9
    v_exp_f32 v170, v10
    v_exp_f32 v171, v11
    s_bfe_u32 s63, s62, 0x80008
    s_add_u32 s64, s10, 8
    s_and_b32 s69, s62, 0x7c
    s_cmp_ge_u32 s63, s64
    s_cselect_b32 s12, s69, s10
    v_mfma_f32_32x32x16_bf16 v[20:35], v[128:131], v[104:107], v[20:35]
    v_exp_f32 v172, v12
    v_exp_f32 v173, v13
    v_exp_f32 v174, v14
    v_exp_f32 v175, v15
    v_exp_f32 v176, v16
    s_waitcnt vmcnt(1)
    ds_read_b128 v[116:119], v220
    ds_read_b128 v[120:123], v221
    ds_read_b128 v[124:127], v222
    ds_read_b128 v[128:131], v223
    v_exp_f32 v177, v17
    v_exp_f32 v178, v18
    v_exp_f32 v179, v19
    v_pk_add_f32 v[164:165], v[164:165], s[60:61]
    v_pk_add_f32 v[166:167], v[166:167], s[60:61]
    v_pk_add_f32 v[168:169], v[168:169], s[60:61]
    v_pk_add_f32 v[170:171], v[170:171], s[60:61]
    v_pk_add_f32 v[172:173], v[172:173], s[60:61]
    v_pk_add_f32 v[174:175], v[174:175], s[60:61]
    v_pk_add_f32 v[176:177], v[176:177], s[60:61]
    v_pk_add_f32 v[178:179], v[178:179], s[60:61]
    v_mfma_f32_32x32x16_bf16 v[20:35], v[132:135], v[112:115], v[20:35]
    v_rcp_f32 v164, v164
    v_rcp_f32 v165, v165
    v_rcp_f32 v166, v166
    s_waitcnt lgkmcnt(4)
    v_and_or_b32 v144, v144, s6, v224
    v_and_or_b32 v145, v145, s6, v225
    v_and_or_b32 v146, v146, s6, v226
    v_and_or_b32 v147, v147, s6, v227
    v_rcp_f32 v167, v167
    v_rcp_f32 v168, v168
    s_waitcnt lgkmcnt(0)
    buffer_load_dwordx4 v144, s[28:31], s7 offen offset:0 lds
    buffer_load_dwordx4 v145, s[28:31], s8 offen offset:1024 lds
    buffer_load_dwordx4 v146, s[28:31], s9 offen offset:2048 lds
    buffer_load_dwordx4 v147, s[28:31], 0 offen offset:3072 lds
    v_mfma_f32_32x32x16_bf16 v[52:67], v[156:159], v[136:139], v[52:67]
    v_rcp_f32 v169, v169
    v_rcp_f32 v170, v170
    ds_read2_b32 v[132:133], v228 offset0:96 offset1:97
    s_cmp_eq_u32 s12, s10
    s_cbranch_scc1 L_noaw
    s_add_u32 s63, s12, 4
    s_lshr_b32 s63, s63, 3
    s_lshl_b32 s63, s63, 10
    s_lshr_b32 s64, s12, 3
    s_lshl_b32 s64, s64, 10
    v_add_u32 v2, s63, v233
    v_add_u32 v3, s64, v233
    s_mov_b64 exec, s[16:17]
    ds_read_b64 v[108:109], v2
    ds_read_b64 v[110:111], v3 offset:8
    ds_read_b64 v[112:113], v2 offset:512
    ds_read_b64 v[114:115], v3 offset:520
    s_mov_b64 exec, -1
L_noaw:
    v_rcp_f32 v171, v171
    v_rcp_f32 v172, v172
    v_rcp_f32 v173, v173
    v_mfma_f32_32x32x16_bf16 v[52:67], v[160:163], v[140:143], v[52:67]
    v_rcp_f32 v174, v174
    v_rcp_f32 v175, v175
    ds_read_b64_tr_b16 v[136:137], v231
    ds_read_b64_tr_b16 v[138:139], v232
    ds_read_b64_tr_b16 v[140:141], v231 offset:1024
    ds_read_b64_tr_b16 v[142:143], v232 offset:1024
    ds_write2_b32 v242, v235, v235 offset0:0 offset1:1
    v_rcp_f32 v176, v176
    v_rcp_f32 v177, v177
    v_rcp_f32 v178, v178
    v_rcp_f32 v179, v179
    v_pk_mul_f32 v[164:165], v[164:165], v[4:5]
    v_pk_mul_f32 v[166:167], v[166:167], v[6:7]
    v_pk_mul_f32 v[168:169], v[168:169], v[8:9]
    v_pk_mul_f32 v[170:171], v[170:171], v[10:11]
    v_pk_mul_f32 v[172:173], v[172:173], v[12:13]
    v_pk_mul_f32 v[174:175], v[174:175], v[14:15]
    v_pk_mul_f32 v[176:177], v[176:177], v[16:17]
    v_pk_mul_f32 v[178:179], v[178:179], v[18:19]
    v_cvt_pk_bf16_f32 v148, v164, v165
    v_cvt_pk_bf16_f32 v149, v166, v167
    v_cvt_pk_bf16_f32 v150, v168, v169
    v_cvt_pk_bf16_f32 v151, v170, v171
    v_cvt_pk_bf16_f32 v152, v172, v173
    v_cvt_pk_bf16_f32 v153, v174, v175
    v_cvt_pk_bf16_f32 v154, v176, v177
    v_cvt_pk_bf16_f32 v155, v178, v179
    s_cmp_eq_u32 s10, s11
    s_cbranch_scc1 L_noflush
    s_mov_b32 s14, 0xffff
    s_bitcmp1_b32 s11, 2
    s_cselect_b32 s14, 0xffff0000, s14
    s_add_u32 s63, s11, 4
    s_cmp_eq_u32 s63, s10
    s_cselect_b32 s14, s14, -1
    s_cmp_lg_u32 s56, 0
    s_cbranch_scc1 L_flush_slow
    s_lshr_b32 s63, s11, 3
    s_mul_i32 s63, s63, 2176
    s_bitcmp1_b32 s11, 2
    s_cselect_b32 s64, 2176, 0
    v_and_b32 v3, s64, v238
    v_add3_u32 v2, v236, v3, s63
    v_add3_u32 v3, v237, v3, s63
    s_and_b32 exec_lo, s14, 0x88888888
    s_mov_b32 exec_hi, exec_lo
    ds_write_b128 v2, v[36:39] offset:0
    ds_write_b128 v2, v[40:43] offset:32
    ds_write_b128 v2, v[44:47] offset:64
    ds_write_b128 v2, v[48:51] offset:96
    ds_write_b128 v2, v[52:55] offset:128
    ds_write_b128 v2, v[56:59] offset:160
    ds_write_b128 v2, v[60:63] offset:192
    ds_write_b128 v2, v[64:67] offset:224
    s_mov_b64 exec, -1
    v_pk_mul_f32 v[164:165], v[68:69], v[36:37]
    v_pk_mul_f32 v[166:167], v[84:85], v[52:53]
    v_pk_fma_f32 v[164:165], v[70:71], v[38:39], v[164:165]
    v_pk_fma_f32 v[166:167], v[86:87], v[54:55], v[166:167]
    v_pk_fma_f32 v[164:165], v[72:73], v[40:41], v[164:165]
    v_pk_fma_f32 v[166:167], v[88:89], v[56:57], v[166:167]
    v_pk_fma_f32 v[164:165], v[74:75], v[42:43], v[164:165]
    v_pk_fma_f32 v[166:167], v[90:91], v[58:59], v[166:167]
    v_pk_fma_f32 v[164:165], v[76:77], v[44:45], v[164:165]
    v_pk_fma_f32 v[166:167], v[92:93], v[60:61], v[166:167]
    v_pk_fma_f32 v[164:165], v[78:79], v[46:47], v[164:165]
    v_pk_fma_f32 v[166:167], v[94:95], v[62:63], v[166:167]
    v_pk_fma_f32 v[164:165], v[80:81], v[48:49], v[164:165]
    v_pk_fma_f32 v[166:167], v[96:97], v[64:65], v[166:167]
    v_pk_fma_f32 v[164:165], v[82:83], v[50:51], v[164:165]
    v_pk_fma_f32 v[166:167], v[98:99], v[66:67], v[166:167]
    v_pk_add_f32 v[164:165], v[164:165], v[166:167]
    v_add_f32 v243, v164, v165
    v_add_f32 v244, v164, v165
    s_nop 1
    v_permlane32_swap_b32 v243, v244
    s_nop 1
    v_add_f32 v243, v243, v244
    s_and_b32 exec_lo, s14, 0x77777777
    s_mov_b32 exec_hi, 0
    ds_write_b32 v3, v243
    s_mov_b32 exec_lo, s14
    s_mov_b32 exec_hi, s14
    v_mov_b64 v[36:37], 0
    v_mov_b64 v[38:39], 0
    v_mov_b64 v[40:41], 0
    v_mov_b64 v[42:43], 0
    v_mov_b64 v[44:45], 0
    v_mov_b64 v[46:47], 0
    v_mov_b64 v[48:49], 0
    v_mov_b64 v[50:51], 0
    v_mov_b64 v[52:53], 0
    v_mov_b64 v[54:55], 0
    v_mov_b64 v[56:57], 0
    v_mov_b64 v[58:59], 0
    v_mov_b64 v[60:61], 0
    v_mov_b64 v[62:63], 0
    v_mov_b64 v[64:65], 0
    v_mov_b64 v[66:67], 0
    s_mov_b64 exec, -1
L_noflush:
    s_mov_b32 s11, s10
    s_mov_b32 s10, s12
    s_lshr_b32 s68, s62, 16
    s_waitcnt vmcnt(4)
    v_dot2_f32_bf16 v2, v216, s4, v212
    v_dot2_f32_bf16 v3, v216, s5, v213
    v_dot2_f32_bf16 v243, v217, s4, v214
    v_xor_b32 v242, v230, v215
    v_lshrrev_b32 v240, 7, v239
    buffer_load_dwordx2 v[216:217], v240, s[32:35], 0 idxen
    v_cvt_pk_bf16_f32 v218, v2, v3
    v_cvt_pk_bf16_f32 v244, v243, 0
    v_cvt_pk_bf16_f32 v219, v243, 1.0
    v_dot2_f32_bf16 v2, v218, v218, 0
    v_dot2_f32_bf16 v2, v244, v244, v2
    v_add_u32 v228, 384, v228
    v_add_u32 v229, 384, v229
    s_nop 0
    v_cvt_pk_bf16_f32 v134, v2, v2
    s_mov_b64 exec, s[16:17]
    ds_read_b128 v[132:135], v241
    s_mov_b64 exec, -1
    v_lshlrev_b32_sdwa v241, 5, v239 dst_sel:DWORD dst_unused:UNUSED_PAD src0_sel:DWORD src1_sel:BYTE_0
    v_exp_f32 v164, v20
    v_exp_f32 v165, v21
    v_mfma_f32_32x32x16_bf16 v[4:19], v[116:119], v[100:103], 0
    v_exp_f32 v166, v22
    v_exp_f32 v167, v23
    v_exp_f32 v168, v24
    v_exp_f32 v169, v25
    v_exp_f32 v170, v26
    v_exp_f32 v171, v27
    v_mfma_f32_32x32x16_bf16 v[4:19], v[120:123], v[104:107], v[4:19]
    v_exp_f32 v172, v28
    v_exp_f32 v173, v29
    v_exp_f32 v174, v30
    v_exp_f32 v175, v31
    v_exp_f32 v176, v32
    v_exp_f32 v177, v33
    v_exp_f32 v178, v34
    v_exp_f32 v179, v35
    s_waitcnt lgkmcnt(0)
    v_pk_add_f32 v[164:165], v[164:165], s[60:61]
    v_pk_add_f32 v[166:167], v[166:167], s[60:61]
    v_pk_add_f32 v[168:169], v[168:169], s[60:61]
    v_pk_add_f32 v[170:171], v[170:171], s[60:61]
    v_pk_add_f32 v[172:173], v[172:173], s[60:61]
    v_pk_add_f32 v[174:175], v[174:175], s[60:61]
    v_pk_add_f32 v[176:177], v[176:177], s[60:61]
    v_pk_add_f32 v[178:179], v[178:179], s[60:61]
    v_mfma_f32_32x32x16_bf16 v[4:19], v[132:135], v[108:111], v[4:19]
    v_rcp_f32 v164, v164
    v_rcp_f32 v165, v165
    v_rcp_f32 v166, v166
    v_rcp_f32 v167, v167
    v_rcp_f32 v168, v168
    v_mfma_f32_32x32x16_bf16 v[36:51], v[148:151], v[136:139], v[36:51]
    v_rcp_f32 v169, v169
    v_rcp_f32 v170, v170
    v_rcp_f32 v171, v171
    v_rcp_f32 v172, v172
    v_rcp_f32 v173, v173
    v_mfma_f32_32x32x16_bf16 v[36:51], v[152:155], v[140:143], v[36:51]
    v_rcp_f32 v174, v174
    v_rcp_f32 v175, v175
    v_rcp_f32 v176, v176
    v_rcp_f32 v177, v177
    v_rcp_f32 v178, v178
    v_rcp_f32 v179, v179
    v_pk_mul_f32 v[164:165], v[164:165], v[20:21]
    v_pk_mul_f32 v[166:167], v[166:167], v[22:23]
    v_pk_mul_f32 v[168:169], v[168:169], v[24:25]
    v_pk_mul_f32 v[170:171], v[170:171], v[26:27]
    v_pk_mul_f32 v[172:173], v[172:173], v[28:29]
    v_pk_mul_f32 v[174:175], v[174:175], v[30:31]
    v_pk_mul_f32 v[176:177], v[176:177], v[32:33]
    v_pk_mul_f32 v[178:179], v[178:179], v[34:35]
    v_cvt_pk_bf16_f32 v156, v164, v165
    v_cvt_pk_bf16_f32 v157, v166, v167
    v_cvt_pk_bf16_f32 v158, v168, v169
    v_cvt_pk_bf16_f32 v159, v170, v171
    v_cvt_pk_bf16_f32 v160, v172, v173
    v_cvt_pk_bf16_f32 v161, v174, v175
    v_cvt_pk_bf16_f32 v162, v176, v177
    v_cvt_pk_bf16_f32 v163, v178, v179
    s_sub_u32 s63, s67, 1
    s_add_u32 s67, s67, 1
    s_cmp_le_u32 s67, s66
    s_cbranch_scc1 L_loop
    v_readlane_b32 s62, v234, s63
    v_mfma_f32_32x32x16_bf16 v[52:67], v[156:159], v[136:139], v[52:67]
    v_mfma_f32_32x32x16_bf16 v[52:67], v[160:163], v[140:143], v[52:67]
    s_setprio 0
    s_mov_b32 s14, 0xffff
    s_bitcmp1_b32 s11, 2
    s_cselect_b32 s14, 0xffff0000, s14
    s_bfe_u32 s12, s62, 0x6000a
    s_lshr_b32 s64, s11, 2
    s_cmp_lg_u32 s12, s64
    s_cselect_b32 s14, -1, s14
    s_mov_b32 s69, 0xffff
    s_bitcmp1_b32 s12, 0
    s_cselect_b32 s69, 0xffff0000, s69
    s_cselect_b32 s68, 1088, 0
    s_lshr_b32 s63, s11, 3
    s_mul_i32 s63, s63, 2176
    s_bitcmp1_b32 s11, 2
    s_cselect_b32 s64, 2176, 0
    v_and_b32 v3, s64, v238
    v_add3_u32 v2, v236, v3, s63
    v_add3_u32 v3, v237, v3, s63
    s_cmp_lg_u32 s56, 0
    s_cbranch_scc1 L_final_slow
    s_lshl_b32 s63, s52, 11
    s_add_u32 s63, s63, 86016
    v_add_u32 v239, s63, v253
    s_sub_u32 s63, s63, 115712
    s_sub_u32 s63, s63, s68
    s_mov_b32 exec_lo, s69
    s_mov_b32 exec_hi, s69
    v_add_u32 v2, s63, v236
    s_and_b32 exec_lo, s14, 0x88888888
    s_mov_b32 exec_hi, exec_lo
    ds_write_b128 v2, v[36:39] offset:0
    ds_write_b128 v2, v[40:43] offset:32
    ds_write_b128 v2, v[44:47] offset:64
    ds_write_b128 v2, v[48:51] offset:96
    ds_write_b128 v2, v[52:55] offset:128
    ds_write_b128 v2, v[56:59] offset:160
    ds_write_b128 v2, v[60:63] offset:192
    ds_write_b128 v2, v[64:67] offset:224
    s_mov_b64 exec, -1
    ds_read_b128 v[212:215], v239
    v_pk_mul_f32 v[164:165], v[68:69], v[36:37]
    v_pk_mul_f32 v[166:167], v[84:85], v[52:53]
    v_pk_fma_f32 v[164:165], v[70:71], v[38:39], v[164:165]
    v_pk_fma_f32 v[166:167], v[86:87], v[54:55], v[166:167]
    v_pk_fma_f32 v[164:165], v[72:73], v[40:41], v[164:165]
    v_pk_fma_f32 v[166:167], v[88:89], v[56:57], v[166:167]
    v_pk_fma_f32 v[164:165], v[74:75], v[42:43], v[164:165]
    v_pk_fma_f32 v[166:167], v[90:91], v[58:59], v[166:167]
    v_pk_fma_f32 v[164:165], v[76:77], v[44:45], v[164:165]
    v_pk_fma_f32 v[166:167], v[92:93], v[60:61], v[166:167]
    v_pk_fma_f32 v[164:165], v[78:79], v[46:47], v[164:165]
    v_pk_fma_f32 v[166:167], v[94:95], v[62:63], v[166:167]
    v_pk_fma_f32 v[164:165], v[80:81], v[48:49], v[164:165]
    v_pk_fma_f32 v[166:167], v[96:97], v[64:65], v[166:167]
    v_pk_fma_f32 v[164:165], v[82:83], v[50:51], v[164:165]
    v_pk_fma_f32 v[166:167], v[98:99], v[66:67], v[166:167]
    v_pk_add_f32 v[164:165], v[164:165], v[166:167]
    v_add_f32 v243, v164, v165
    v_add_f32 v244, v164, v165
    s_nop 1
    v_permlane32_swap_b32 v243, v244
    s_nop 1
    v_add_f32 v243, v243, v244
    ds_read_b64_tr_b16 v[68:69], v252 offset:8192
    ds_read_b64_tr_b16 v[70:71], v252 offset:8704
    ds_read_b64_tr_b16 v[72:73], v252 offset:10240
    ds_read_b64_tr_b16 v[74:75], v252 offset:10752
    ds_read_b64_tr_b16 v[76:77], v252 offset:12288
    ds_read_b64_tr_b16 v[78:79], v252 offset:12800
    ds_read_b64_tr_b16 v[80:81], v252 offset:14336
    ds_read_b64_tr_b16 v[82:83], v252 offset:14848
    s_andn2_b32 s63, s14, s69
    s_and_b32 exec_lo, s63, 0x77777777
    s_mov_b32 exec_hi, 0
    ds_write_b32 v3, v243
    s_mov_b64 exec, -1
    s_mov_b32 s14, s69
    s_mul_i32 s63, s12, 1088
    s_add_u32 s63, s63, 115712
    v_add_u32 v2, s63, v253
    s_ashr_i32 s13, s13, 2
    s_cmp_lg_u32 s13, s12
    s_cbranch_scc1 L_main_end
    s_add_u32 s63, s18, 146440
    v_mov_b32 v239, s63
    v_mov_b32 v240, 1
    ds_write_b32 v239, v240
L_main_end:
    v_mov_b32 v239, 146440
    s_waitcnt vmcnt(0) lgkmcnt(0)
    s_barrier
    ds_read_b64 v[216:217], v239
    ds_read_b128 v[4:7], v2
    s_and_b32 exec_lo, s14, 0x77777777
    s_mov_b32 exec_hi, 0
    ds_read_b32 v244, v3
    s_mov_b64 exec, -1
    s_waitcnt lgkmcnt(2)
    v_readfirstlane_b32 s63, v216
    v_readfirstlane_b32 s64, v217
    s_nop 3
    s_or_b32 s62, s63, s64
    s_cbranch_scc1 L_merge_rare
L_merge:
    s_cmp_eq_u32 s66, 0
    s_cbranch_scc1 L_epi
    s_waitcnt lgkmcnt(1)
    v_pk_add_f32 v[4:5], v[4:5], v[212:213]
    v_pk_add_f32 v[6:7], v[6:7], v[214:215]
    ds_write_b128 v2, v[4:7]
    s_and_b32 exec_lo, s14, 0x77777777
    s_mov_b32 exec_hi, 0
    s_waitcnt lgkmcnt(1)
    v_add_f32 v243, v243, v244
    ds_write_b32 v3, v243
    s_mov_b64 exec, -1
L_epi:
    s_mov_b32 s62, 0xbf317218
    s_mov_b32 s63, 0xbf317218
    ds_read_b32 v239, v247 offset:16
    s_waitcnt lgkmcnt(0)
    s_barrier
    ds_read_b128 v[4:7], v246 offset:0
    ds_read_b128 v[8:11], v246 offset:16
    ds_read_b128 v[12:15], v246 offset:64
    ds_read_b128 v[16:19], v246 offset:80
    ds_read_b128 v[20:23], v246 offset:128
    ds_read_b128 v[24:27], v246 offset:144
    ds_read_b128 v[28:31], v246 offset:192
    ds_read_b128 v[32:35], v246 offset:208
    ds_read_b32 v240, v248
    s_waitcnt lgkmcnt(7)
    v_cvt_pk_bf16_f32 v116, v4, v5
    v_cvt_pk_bf16_f32 v117, v6, v7
    v_cvt_pk_bf16_f32 v118, v8, v9
    v_cvt_pk_bf16_f32 v119, v10, v11
    s_waitcnt lgkmcnt(5)
    v_cvt_pk_bf16_f32 v120, v12, v13
    v_cvt_pk_bf16_f32 v121, v14, v15
    v_cvt_pk_bf16_f32 v122, v16, v17
    v_cvt_pk_bf16_f32 v123, v18, v19
    v_mfma_f32_32x32x16_bf16 v[180:195], v[68:71], v[116:119], v[180:195]
    s_waitcnt lgkmcnt(3)
    v_cvt_pk_bf16_f32 v124, v20, v21
    v_cvt_pk_bf16_f32 v125, v22, v23
    v_cvt_pk_bf16_f32 v126, v24, v25
    v_cvt_pk_bf16_f32 v127, v26, v27
    v_mfma_f32_32x32x16_bf16 v[180:195], v[72:75], v[120:123], v[180:195]
    s_waitcnt lgkmcnt(1)
    v_cvt_pk_bf16_f32 v128, v28, v29
    v_cvt_pk_bf16_f32 v129, v30, v31
    v_cvt_pk_bf16_f32 v130, v32, v33
    v_cvt_pk_bf16_f32 v131, v34, v35
    v_mfma_f32_32x32x16_bf16 v[180:195], v[76:79], v[124:127], v[180:195]
    s_waitcnt lgkmcnt(0)
    v_add_f32 v239, v239, v240
    v_mfma_f32_32x32x16_bf16 v[180:195], v[80:83], v[128:131], v[180:195]
    v_cvt_pk_bf16_f32 v239, v239, v239
    buffer_store_short v239, v245, s[48:51], 0 offen
    s_nop 9
    v_exp_f32 v164, v180
    v_exp_f32 v165, v181
    v_exp_f32 v166, v182
    v_exp_f32 v167, v183
    v_exp_f32 v168, v184
    v_exp_f32 v169, v185
    v_exp_f32 v170, v186
    v_exp_f32 v171, v187
    v_exp_f32 v172, v188
    v_exp_f32 v173, v189
    v_exp_f32 v174, v190
    v_exp_f32 v175, v191
    v_exp_f32 v176, v192
    v_exp_f32 v177, v193
    v_exp_f32 v178, v194
    v_exp_f32 v179, v195
    v_pk_add_f32 v[164:165], v[164:165], s[60:61]
    v_pk_add_f32 v[166:167], v[166:167], s[60:61]
    v_pk_add_f32 v[168:169], v[168:169], s[60:61]
    v_pk_add_f32 v[170:171], v[170:171], s[60:61]
    v_pk_add_f32 v[172:173], v[172:173], s[60:61]
    v_pk_add_f32 v[174:175], v[174:175], s[60:61]
    v_pk_add_f32 v[176:177], v[176:177], s[60:61]
    v_pk_add_f32 v[178:179], v[178:179], s[60:61]
    v_pk_mul_f32 v[180:181], v[180:181], s[62:63]
    v_pk_mul_f32 v[182:183], v[182:183], s[62:63]
    v_pk_mul_f32 v[184:185], v[184:185], s[62:63]
    v_pk_mul_f32 v[186:187], v[186:187], s[62:63]
    v_pk_mul_f32 v[188:189], v[188:189], s[62:63]
    v_pk_mul_f32 v[190:191], v[190:191], s[62:63]
    v_pk_mul_f32 v[192:193], v[192:193], s[62:63]
    v_pk_mul_f32 v[194:195], v[194:195], s[62:63]
    v_rcp_f32 v164, v164
    v_rcp_f32 v165, v165
    v_rcp_f32 v166, v166
    v_rcp_f32 v167, v167
    v_rcp_f32 v168, v168
    v_rcp_f32 v169, v169
    v_rcp_f32 v170, v170
    v_rcp_f32 v171, v171
    v_rcp_f32 v172, v172
    v_rcp_f32 v173, v173
    v_rcp_f32 v174, v174
    v_rcp_f32 v175, v175
    v_rcp_f32 v176, v176
    v_rcp_f32 v177, v177
    v_rcp_f32 v178, v178
    v_rcp_f32 v179, v179
    v_pk_fma_f32 v[164:165], v[164:165], v[180:181], v[196:197]
    v_pk_fma_f32 v[166:167], v[166:167], v[182:183], v[198:199]
    v_cvt_pk_bf16_f32 v148, v164, v165
    v_cvt_pk_bf16_f32 v149, v166, v167
    ds_write_b64 v249, v[148:149] offset:0
    v_pk_fma_f32 v[168:169], v[168:169], v[184:185], v[200:201]
    v_pk_fma_f32 v[170:171], v[170:171], v[186:187], v[202:203]
    v_cvt_pk_bf16_f32 v150, v168, v169
    v_cvt_pk_bf16_f32 v151, v170, v171
    ds_write_b64 v249, v[150:151] offset:16
    v_pk_fma_f32 v[172:173], v[172:173], v[188:189], v[204:205]
    v_pk_fma_f32 v[174:175], v[174:175], v[190:191], v[206:207]
    v_cvt_pk_bf16_f32 v152, v172, v173
    v_cvt_pk_bf16_f32 v153, v174, v175
    ds_write_b64 v249, v[152:153] offset:32
    v_pk_fma_f32 v[176:177], v[176:177], v[192:193], v[208:209]
    v_pk_fma_f32 v[178:179], v[178:179], v[194:195], v[210:211]
    v_cvt_pk_bf16_f32 v154, v176, v177
    v_cvt_pk_bf16_f32 v155, v178, v179
    ds_write_b64 v249, v[154:155] offset:48
    ds_read_b128 v[116:119], v250
    ds_read_b128 v[120:123], v250 offset:1280
    s_waitcnt lgkmcnt(1)
    buffer_store_dwordx4 v[116:119], v251, s[44:47], 0 offen
    s_waitcnt lgkmcnt(0)
    buffer_store_dwordx4 v[120:123], v251, s[44:47], 0 offen offset:2048
L_done:
    s_endpgm
L_noaz:
    s_waitcnt lgkmcnt(0)
    s_branch L_azd
L_idle:
    s_cmp_lg_u32 s56, 0
    s_cbranch_scc1 L_slow_next
    ds_read_b64_tr_b16 v[164:165], v252 offset:0
    ds_read_b64_tr_b16 v[166:167], v252 offset:512
    ds_read_b64_tr_b16 v[168:169], v252 offset:2048
    ds_read_b64_tr_b16 v[170:171], v252 offset:2560
    ds_read_b64_tr_b16 v[172:173], v252 offset:4096
    ds_read_b64_tr_b16 v[174:175], v252 offset:4608
    ds_read_b64_tr_b16 v[176:177], v252 offset:6144
    ds_read_b64_tr_b16 v[178:179], v252 offset:6656
    s_waitcnt lgkmcnt(0)
    v_mfma_f32_32x32x16_bf16 v[180:195], v[164:167], v[116:119], 0
    v_mfma_f32_32x32x16_bf16 v[180:195], v[168:171], v[120:123], v[180:195]
    v_mfma_f32_32x32x16_bf16 v[180:195], v[172:175], v[124:127], v[180:195]
    v_mfma_f32_32x32x16_bf16 v[180:195], v[176:179], v[128:131], v[180:195]
    s_nop 7
    s_nop 3
    v_pk_mul_f32 v[180:181], v[180:181], s[58:59]
    v_pk_mul_f32 v[182:183], v[182:183], s[58:59]
    v_pk_mul_f32 v[184:185], v[184:185], s[58:59]
    v_pk_mul_f32 v[186:187], v[186:187], s[58:59]
    v_pk_mul_f32 v[188:189], v[188:189], s[58:59]
    v_pk_mul_f32 v[190:191], v[190:191], s[58:59]
    v_pk_mul_f32 v[192:193], v[192:193], s[58:59]
    v_pk_mul_f32 v[194:195], v[194:195], s[58:59]
    ds_read_b64_tr_b16 v[68:69], v252 offset:8192
    ds_read_b64_tr_b16 v[70:71], v252 offset:8704
    ds_read_b64_tr_b16 v[72:73], v252 offset:10240
    ds_read_b64_tr_b16 v[74:75], v252 offset:10752
    ds_read_b64_tr_b16 v[76:77], v252 offset:12288
    ds_read_b64_tr_b16 v[78:79], v252 offset:12800
    ds_read_b64_tr_b16 v[80:81], v252 offset:14336
    ds_read_b64_tr_b16 v[82:83], v252 offset:14848
    s_branch L_main_end
L_merge_rare:
    s_cmp_lg_u32 s63, 0
    s_cbranch_scc1 L_final_atomic
    s_cmp_ge_u32 s52, 4
    s_cbranch_scc1 L_merge_young
    s_cmp_eq_u32 s66, 0
    s_cbranch_scc1 L_merge_old_done
    s_waitcnt lgkmcnt(1)
    v_pk_add_f32 v[4:5], v[4:5], v[212:213]
    v_pk_add_f32 v[6:7], v[6:7], v[214:215]
    ds_write_b128 v2, v[4:7]
    s_and_b32 exec_lo, s14, 0x77777777
    s_mov_b32 exec_hi, 0
    s_waitcnt lgkmcnt(1)
    v_add_f32 v243, v243, v244
    ds_write_b32 v3, v243
    s_mov_b64 exec, -1
L_merge_old_done:
    s_waitcnt lgkmcnt(0)
    s_barrier
    s_branch L_epi
L_merge_young:
    s_waitcnt lgkmcnt(0)
    s_barrier
    ds_read_b128 v[4:7], v2
    s_and_b32 exec_lo, s14, 0x77777777
    s_mov_b32 exec_hi, 0
    ds_read_b32 v244, v3
    s_mov_b64 exec, -1
    s_branch L_merge
L_final_atomic:
    s_cmp_eq_u32 s66, 0
    s_cbranch_scc1 L_epi
    ds_add_f32 v2, v212 offset:0
    ds_add_f32 v2, v213 offset:4
    ds_add_f32 v2, v214 offset:8
    ds_add_f32 v2, v215 offset:12
    s_and_b32 exec_lo, s14, 0x77777777
    s_mov_b32 exec_hi, 0
    ds_add_f32 v3, v243
    s_mov_b64 exec, -1
    s_branch L_epi
L_final_slow:
    s_waitcnt vmcnt(0) lgkmcnt(0)
    v_pk_mul_f32 v[164:165], v[68:69], v[36:37]
    v_pk_mul_f32 v[166:167], v[84:85], v[52:53]
    v_pk_fma_f32 v[164:165], v[70:71], v[38:39], v[164:165]
    v_pk_fma_f32 v[166:167], v[86:87], v[54:55], v[166:167]
    v_pk_fma_f32 v[164:165], v[72:73], v[40:41], v[164:165]
    v_pk_fma_f32 v[166:167], v[88:89], v[56:57], v[166:167]
    v_pk_fma_f32 v[164:165], v[74:75], v[42:43], v[164:165]
    v_pk_fma_f32 v[166:167], v[90:91], v[58:59], v[166:167]
    v_pk_fma_f32 v[164:165], v[76:77], v[44:45], v[164:165]
    v_pk_fma_f32 v[166:167], v[92:93], v[60:61], v[166:167]
    v_pk_fma_f32 v[164:165], v[78:79], v[46:47], v[164:165]
    v_pk_fma_f32 v[166:167], v[94:95], v[62:63], v[166:167]
    v_pk_fma_f32 v[164:165], v[80:81], v[48:49], v[164:165]
    v_pk_fma_f32 v[166:167], v[96:97], v[64:65], v[166:167]
    v_pk_fma_f32 v[164:165], v[82:83], v[50:51], v[164:165]
    v_pk_fma_f32 v[166:167], v[98:99], v[66:67], v[166:167]
    v_pk_add_f32 v[164:165], v[164:165], v[166:167]
    v_add_f32 v243, v164, v165
    v_add_f32 v244, v164, v165
    s_nop 1
    v_permlane32_swap_b32 v243, v244
    s_nop 1
    v_add_f32 v243, v243, v244
    s_and_b32 exec_lo, s14, 0x88888888
    s_mov_b32 exec_hi, exec_lo
    ds_add_f32 v2, v36 offset:0
    ds_add_f32 v2, v37 offset:4
    ds_add_f32 v2, v38 offset:8
    ds_add_f32 v2, v39 offset:12
    ds_add_f32 v2, v40 offset:32
    ds_add_f32 v2, v41 offset:36
    ds_add_f32 v2, v42 offset:40
    ds_add_f32 v2, v43 offset:44
    ds_add_f32 v2, v44 offset:64
    ds_add_f32 v2, v45 offset:68
    ds_add_f32 v2, v46 offset:72
    ds_add_f32 v2, v47 offset:76
    ds_add_f32 v2, v48 offset:96
    ds_add_f32 v2, v49 offset:100
    ds_add_f32 v2, v50 offset:104
    ds_add_f32 v2, v51 offset:108
    ds_add_f32 v2, v52 offset:128
    ds_add_f32 v2, v53 offset:132
    ds_add_f32 v2, v54 offset:136
    ds_add_f32 v2, v55 offset:140
    ds_add_f32 v2, v56 offset:160
    ds_add_f32 v2, v57 offset:164
    ds_add_f32 v2, v58 offset:168
    ds_add_f32 v2, v59 offset:172
    ds_add_f32 v2, v60 offset:192
    ds_add_f32 v2, v61 offset:196
    ds_add_f32 v2, v62 offset:200
    ds_add_f32 v2, v63 offset:204
    ds_add_f32 v2, v64 offset:224
    ds_add_f32 v2, v65 offset:228
    ds_add_f32 v2, v66 offset:232
    ds_add_f32 v2, v67 offset:236
    s_and_b32 exec_lo, s14, 0x77777777
    s_mov_b32 exec_hi, 0
    ds_add_f32 v3, v243
    s_mov_b64 exec, -1
    s_branch L_slow_next
L_flush_slow:
    s_lshr_b32 s63, s11, 3
    s_mul_i32 s63, s63, 2176
    s_bitcmp1_b32 s11, 2
    s_cselect_b32 s64, 2176, 0
    v_and_b32 v3, s64, v238
    v_add3_u32 v2, v236, v3, s63
    v_add3_u32 v3, v237, v3, s63
    s_waitcnt lgkmcnt(0)
    v_pk_mul_f32 v[164:165], v[68:69], v[36:37]
    v_pk_mul_f32 v[166:167], v[84:85], v[52:53]
    v_pk_fma_f32 v[164:165], v[70:71], v[38:39], v[164:165]
    v_pk_fma_f32 v[166:167], v[86:87], v[54:55], v[166:167]
    v_pk_fma_f32 v[164:165], v[72:73], v[40:41], v[164:165]
    v_pk_fma_f32 v[166:167], v[88:89], v[56:57], v[166:167]
    v_pk_fma_f32 v[164:165], v[74:75], v[42:43], v[164:165]
    v_pk_fma_f32 v[166:167], v[90:91], v[58:59], v[166:167]
    v_pk_fma_f32 v[164:165], v[76:77], v[44:45], v[164:165]
    v_pk_fma_f32 v[166:167], v[92:93], v[60:61], v[166:167]
    v_pk_fma_f32 v[164:165], v[78:79], v[46:47], v[164:165]
    v_pk_fma_f32 v[166:167], v[94:95], v[62:63], v[166:167]
    v_pk_fma_f32 v[164:165], v[80:81], v[48:49], v[164:165]
    v_pk_fma_f32 v[166:167], v[96:97], v[64:65], v[166:167]
    v_pk_fma_f32 v[164:165], v[82:83], v[50:51], v[164:165]
    v_pk_fma_f32 v[166:167], v[98:99], v[66:67], v[166:167]
    v_pk_add_f32 v[164:165], v[164:165], v[166:167]
    v_add_f32 v243, v164, v165
    v_add_f32 v244, v164, v165
    s_nop 1
    v_permlane32_swap_b32 v243, v244
    s_nop 1
    v_add_f32 v243, v243, v244
    s_and_b32 exec_lo, s14, 0x88888888
    s_mov_b32 exec_hi, exec_lo
    ds_add_f32 v2, v36 offset:0
    ds_add_f32 v2, v37 offset:4
    ds_add_f32 v2, v38 offset:8
    ds_add_f32 v2, v39 offset:12
    ds_add_f32 v2, v40 offset:32
    ds_add_f32 v2, v41 offset:36
    ds_add_f32 v2, v42 offset:40
    ds_add_f32 v2, v43 offset:44
    ds_add_f32 v2, v44 offset:64
    ds_add_f32 v2, v45 offset:68
    ds_add_f32 v2, v46 offset:72
    ds_add_f32 v2, v47 offset:76
    ds_add_f32 v2, v48 offset:96
    ds_add_f32 v2, v49 offset:100
    ds_add_f32 v2, v50 offset:104
    ds_add_f32 v2, v51 offset:108
    ds_add_f32 v2, v52 offset:128
    ds_add_f32 v2, v53 offset:132
    ds_add_f32 v2, v54 offset:136
    ds_add_f32 v2, v55 offset:140
    ds_add_f32 v2, v56 offset:160
    ds_add_f32 v2, v57 offset:164
    ds_add_f32 v2, v58 offset:168
    ds_add_f32 v2, v59 offset:172
    ds_add_f32 v2, v60 offset:192
    ds_add_f32 v2, v61 offset:196
    ds_add_f32 v2, v62 offset:200
    ds_add_f32 v2, v63 offset:204
    ds_add_f32 v2, v64 offset:224
    ds_add_f32 v2, v65 offset:228
    ds_add_f32 v2, v66 offset:232
    ds_add_f32 v2, v67 offset:236
    s_and_b32 exec_lo, s14, 0x77777777
    s_mov_b32 exec_hi, 0
    ds_add_f32 v3, v243
    s_mov_b64 exec, -1
    s_mov_b32 exec_lo, s14
    s_mov_b32 exec_hi, s14
    v_mov_b64 v[36:37], 0
    v_mov_b64 v[38:39], 0
    v_mov_b64 v[40:41], 0
    v_mov_b64 v[42:43], 0
    v_mov_b64 v[44:45], 0
    v_mov_b64 v[46:47], 0
    v_mov_b64 v[48:49], 0
    v_mov_b64 v[50:51], 0
    v_mov_b64 v[52:53], 0
    v_mov_b64 v[54:55], 0
    v_mov_b64 v[56:57], 0
    v_mov_b64 v[58:59], 0
    v_mov_b64 v[60:61], 0
    v_mov_b64 v[62:63], 0
    v_mov_b64 v[64:65], 0
    v_mov_b64 v[66:67], 0
    s_mov_b64 exec, -1
    s_branch L_noflush
L_slow:
    s_mov_b32 s56, 1
    s_mov_b32 s57, 0
    s_waitcnt vmcnt(0) lgkmcnt(0)
    s_barrier
    ds_read_b64_tr_b16 v[164:165], v252 offset:0
    ds_read_b64_tr_b16 v[166:167], v252 offset:512
    ds_read_b64_tr_b16 v[168:169], v252 offset:2048
    ds_read_b64_tr_b16 v[170:171], v252 offset:2560
    ds_read_b64_tr_b16 v[172:173], v252 offset:4096
    ds_read_b64_tr_b16 v[174:175], v252 offset:4608
    ds_read_b64_tr_b16 v[176:177], v252 offset:6144
    ds_read_b64_tr_b16 v[178:179], v252 offset:6656
    s_waitcnt lgkmcnt(0)
    v_mfma_f32_32x32x16_bf16 v[180:195], v[164:167], v[116:119], 0
    v_mfma_f32_32x32x16_bf16 v[180:195], v[168:171], v[120:123], v[180:195]
    v_mfma_f32_32x32x16_bf16 v[180:195], v[172:175], v[124:127], v[180:195]
    v_mfma_f32_32x32x16_bf16 v[180:195], v[176:179], v[128:131], v[180:195]
    s_nop 7
    s_nop 3
    v_pk_mul_f32 v[180:181], v[180:181], s[58:59]
    v_pk_mul_f32 v[182:183], v[182:183], s[58:59]
    v_pk_mul_f32 v[184:185], v[184:185], s[58:59]
    v_pk_mul_f32 v[186:187], v[186:187], s[58:59]
    v_pk_mul_f32 v[188:189], v[188:189], s[58:59]
    v_pk_mul_f32 v[190:191], v[190:191], s[58:59]
    v_pk_mul_f32 v[192:193], v[192:193], s[58:59]
    v_pk_mul_f32 v[194:195], v[194:195], s[58:59]
L_slow_round:
    s_waitcnt lgkmcnt(0)
    s_barrier
    v_lshlrev_b32 v2, 2, v0
    v_cmp_gt_u32 vcc, 256, v0
    s_and_saveexec_b64 s[62:63], vcc
    ds_write_b32 v2, v235 offset:8192
    s_mov_b64 exec, -1
    v_mov_b32 v2, 146432
    ds_write_b32 v2, v235
    s_lshl_b32 s63, s57, 10
    s_add_u32 s63, s63, s55
    buffer_load_dword v3, v235, s[40:43], s63 offen sc1
    s_mul_i32 s63, s57, 37632
    v_mul_u32_u24 v244, 12, v0
    s_waitcnt vmcnt(0)
    v_bfe_u32 v243, v3, 16, 15
    v_and_b32 v3, 0xffff, v3
    v_add_u32 v3, v3, v244
    v_mov_b32 v2, v0
    v_cmp_lt_u32 s[70:71], v2, v243
    s_mov_b64 exec, s[70:71]
    buffer_load_dwordx3 v[4:6], v3, s[36:39], s63 offen sc1
    s_mov_b64 exec, -1
    v_add_u32 v2, 512, v2
    s_add_u32 s63, s63, 6144
    v_cmp_lt_u32 s[72:73], v2, v243
    s_mov_b64 exec, s[72:73]
    buffer_load_dwordx3 v[8:10], v3, s[36:39], s63 offen sc1
    s_mov_b64 exec, -1
    v_add_u32 v2, 512, v2
    s_add_u32 s63, s63, 6144
    v_cmp_lt_u32 s[74:75], v2, v243
    s_mov_b64 exec, s[74:75]
    buffer_load_dwordx3 v[12:14], v3, s[36:39], s63 offen sc1
    s_mov_b64 exec, -1
    v_add_u32 v2, 512, v2
    s_add_u32 s63, s63, 6144
    v_cmp_lt_u32 s[76:77], v2, v243
    s_mov_b64 exec, s[76:77]
    buffer_load_dwordx3 v[16:18], v3, s[36:39], s63 offen sc1
    s_mov_b64 exec, -1
    v_add_u32 v2, 512, v2
    s_add_u32 s63, s63, 6144
    v_cmp_lt_u32 s[78:79], v2, v243
    s_mov_b64 exec, s[78:79]
    buffer_load_dwordx3 v[20:22], v3, s[36:39], s63 offen sc1
    s_mov_b64 exec, -1
    v_add_u32 v2, 512, v2
    s_add_u32 s63, s63, 6144
    v_cmp_lt_u32 s[80:81], v2, v243
    s_mov_b64 exec, s[80:81]
    buffer_load_dwordx3 v[24:26], v3, s[36:39], s63 offen sc1
    s_mov_b64 exec, -1
    v_add_u32 v2, 512, v2
    s_add_u32 s63, s63, 6144
    v_cmp_lt_u32 s[82:83], v2, v243
    s_mov_b64 exec, s[82:83]
    buffer_load_dwordx3 v[28:30], v3, s[36:39], s63 offen sc1
    s_mov_b64 exec, -1
    v_add_u32 v2, 512, v2
    s_add_u32 s63, s63, 6144
    s_mov_b64 s[84:85], 0
    s_mov_b64 s[86:87], 0
    s_mov_b64 s[88:89], 0
    s_mov_b64 s[90:91], 0
    s_mov_b64 s[92:93], 0
    s_mov_b64 s[94:95], 0
    s_mov_b64 s[96:97], 0
    s_mov_b64 s[98:99], 0
    s_mov_b64 s[100:101], 0
    v_mov_b32 v218, 1
    s_waitcnt vmcnt(0) lgkmcnt(0)
    s_barrier
    s_branch L_rank
L_slow_next:
    s_add_u32 s57, s57, 1
    s_cmp_lt_u32 s57, 256
    s_cbranch_scc1 L_slow_round
    ds_read_b64_tr_b16 v[68:69], v252 offset:8192
    ds_read_b64_tr_b16 v[70:71], v252 offset:8704
    ds_read_b64_tr_b16 v[72:73], v252 offset:10240
    ds_read_b64_tr_b16 v[74:75], v252 offset:10752
    ds_read_b64_tr_b16 v[76:77], v252 offset:12288
    ds_read_b64_tr_b16 v[78:79], v252 offset:12800
    ds_read_b64_tr_b16 v[80:81], v252 offset:14336
    ds_read_b64_tr_b16 v[82:83], v252 offset:14848
    s_branch L_epi
.section .rodata,"a"
.p2align 6
.amdhsa_kernel gather_scatter__cheap_equivariant_egnn__graph_kernel
  .amdhsa_next_free_vgpr 254
  .amdhsa_next_free_sgpr 102
  .amdhsa_accum_offset 256
  .amdhsa_group_segment_fixed_size 0
  .amdhsa_kernarg_size 88
  .amdhsa_user_sgpr_count 2
  .amdhsa_user_sgpr_kernarg_segment_ptr 1
  .amdhsa_system_sgpr_workgroup_id_x 1
  .amdhsa_float_denorm_mode_32 3
.end_amdhsa_kernel
```
